```python
import torch

def _softmax(x, axis=-1):
    return torch.softmax(x, dim=axis)
def _gelu(x):
    return torch.nn.functional.gelu(x, approximate="tanh")
def _silu(x):
    return torch.nn.functional.silu(x)
def _sigmoid(x):
    return torch.sigmoid(x)
def _layernorm(x, axis=-1, eps=1e-5):
    m = x.mean(dim=axis, keepdim=True)
    v = x.var(dim=axis, keepdim=True, unbiased=False)
    return (x - m) / torch.sqrt(v + eps)
def _scatter_add(tgt, idx, src, axis=0):
    return tgt.clone().index_add_(axis, idx, src)
def _segment_sum(src, seg, n):
    out = torch.zeros((n,) + src.shape[1:], dtype=src.dtype)
    return out.index_add_(0, seg, src)
def _pad(x, pw):
    flat = tuple(v for pair in reversed(pw) for v in pair)
    return torch.nn.functional.pad(x, flat)

kernel_name = 'sequential_preLN__sliding_block__dense_activation_gelu__prompt'

def setup_inputs():

    _w = (lambda a: (lambda t: t.to(torch.bfloat16) if t.is_floating_point() else t)(torch.as_tensor(a)))
    def _A_setup():
        B, S, D = 1, 2048, 640
        return {
            "x": _w((lambda *s: torch.randn(*s, dtype=torch.bfloat16) * 0.05)(B, S, D)),
            "wqkv": _w((lambda *s: torch.randn(*s, dtype=torch.bfloat16) * 0.05)(D, 3 * D)),
            "wo": _w((lambda *s: torch.randn(*s, dtype=torch.bfloat16) * 0.05)(D, D)),
        }
    _A_in = _A_setup()

    def _B_setup():
        B, S, D, F = 1, 2048, 640, 1728
        return {
            "x": _w((lambda *s: torch.randn(*s, dtype=torch.bfloat16) * 0.05)(B, S, D)),
            "w1": _w((lambda *s: torch.randn(*s, dtype=torch.bfloat16) * 0.8)(D, F) * (D ** -0.5)),
            "b1": _w((lambda *s: torch.randn(*s, dtype=torch.bfloat16) * 0.8)(F) * 0.01),
            "w2": _w((lambda *s: torch.randn(*s, dtype=torch.bfloat16) * 0.8)(F, D) * (F ** -0.5)),
            "b2": _w((lambda *s: torch.randn(*s, dtype=torch.bfloat16) * 0.8)(D) * 0.01),
        }
    _B_in = _B_setup()

    return {
        "A_x": _A_in["x"],
        "A_wqkv": _A_in["wqkv"],
        "A_wo": _A_in["wo"],
        "B_x": _B_in["x"],
        "B_w1": _B_in["w1"],
        "B_b1": _B_in["b1"],
        "B_w2": _B_in["w2"],
        "B_b2": _B_in["b2"],
    }

def reference(A_x, A_wqkv, A_wo, B_x, B_w1, B_b1, B_w2, B_b2):
    def _A_ref(x, wqkv, wo):
        B, S, D = x.shape
        H = 32; Dh = D // H; W = 256
        qkv = (lambda x, *d: x.permute(*d))((x @ wqkv).reshape(B, S, 3, H, Dh), 2, 0, 3, 1, 4)
        q, k, v = qkv[0], qkv[1], qkv[2]
        scores = torch.einsum("bhqd,bhkd->bhqk", q, k) * (Dh ** -0.5)
        idx = torch.arange(S)
        mask = (idx[:, None] - idx[None, :] >= 0) & (idx[:, None] - idx[None, :] < W)
        scores = torch.where(mask[None, None], scores, -1e9)
        p = _softmax(scores, axis=-1)
        o = torch.einsum("bhqk,bhkd->bhqd", p, v)
        return (lambda x, *d: x.permute(*d))(o, 0, 2, 1, 3).reshape(B, S, D) @ wo

    def _B_ref(x, w1, b1, w2, b2):
        h = torch.einsum("bsd,df->bsf", x, w1) + b1
        h = _gelu(h)
        return torch.einsum("bsf,fd->bsd", h, w2) + b2

    x = A_x
    h = x + _A_ref(_layernorm(x, axis=-1), A_wqkv, A_wo)
    h2 = h + _B_ref(_layernorm(h, axis=-1), B_w1, B_b1, B_w2, B_b2)
    return h2
```

```asm
; @launch grid=(256,1,1) block=(512,1,1) lds=163840
.amdgcn_target "amdgcn-amd-amdhsa--gfx950"
.text
.globl sequential_preLN__sliding_block__dense_activation_gelu__prompt_kernel
.p2align 8
.type sequential_preLN__sliding_block__dense_activation_gelu__prompt_kernel,@function
sequential_preLN__sliding_block__dense_activation_gelu__prompt_kernel:
    s_getpc_b64 s[100:101]
    s_cmp_ge_u32 s2, 256
    s_cbranch_scc1 L_end
    s_load_dwordx16 s[4:19], s[0:1], 0
    s_load_dwordx4 s[20:23], s[0:1], 64
    s_load_dwordx2 s[24:25], s[0:1], 80
    v_lshrrev_b32 v1, 6, v0
    v_and_b32 v2, 63, v0
    v_readfirstlane_b32 s54, v1
    s_and_b32 s52, s2, 7
    s_lshr_b32 s53, s2, 3
    s_mov_b32 s55, 0
    v_mov_b32 v3, 0
    v_mov_b32 v4, 0
    v_mov_b32 v5, 0
    v_mov_b32 v6, 0
    v_mov_b32 v7, 0
    v_mov_b32 v8, 0
    v_mov_b32 v9, 0
    v_mov_b32 v10, 0
    v_mov_b32 v11, 0
    v_mov_b32 v12, 0
    v_mov_b32 v13, 0
    v_mov_b32 v14, 0
    v_mov_b32 v15, 0
    s_waitcnt lgkmcnt(0)
    s_mov_b32 s28, s4
    s_mov_b32 s29, s5
    s_mov_b32 s30, 0x280000
    s_mov_b32 s31, 0x00020000
    s_mov_b32 s32, s6
    s_mov_b32 s33, s7
    s_mov_b32 s34, 0x258000
    s_mov_b32 s35, 0x00020000
    s_mov_b32 s36, s24
    s_mov_b32 s37, s25
    s_mov_b32 s38, 0x10000000
    s_mov_b32 s39, 0x00020000
    s_mov_b32 s44, s22
    s_mov_b32 s45, s23
    s_mov_b32 s46, 0x100
    s_mov_b32 s47, 0x00020000
    s_mov_b32 s40, s20
    s_mov_b32 s41, s21
    s_mov_b32 s42, 0x280000
    s_mov_b32 s43, 0x00020000
    s_mov_b32 s48, s14
    s_mov_b32 s49, s15
    s_mov_b32 s50, 0xd80
    s_mov_b32 s51, 0x00020000
    s_and_b32 s58, s54, 1
    s_lshr_b32 s59, s54, 1
    s_and_b32 s59, s59, 1
    s_lshl_b32 s3, s52, 8
    s_lshl_b32 s27, s53, 2
    s_add_u32 s27, s27, s3
    v_and_b32 v240, 31, v2
    v_lshlrev_b32 v240, 2, v240
    v_mov_b32 v241, 0
    s_and_b32 s56, s53, 1
    s_lshr_b32 s57, s53, 1
    s_cmp_eq_u32 s54, 7
    s_cbranch_scc1 L_p1_sp
    s_cmp_ge_u32 s53, 30
    s_cbranch_scc1 L_idle
    s_cmp_ge_u32 s54, 4
    s_cbranch_scc1 L_p1_np
    v_and_b32 v14, 15, v2
    v_lshrrev_b32 v15, 4, v2
    v_lshrrev_b32 v3, 1, v14
    v_xor_b32 v3, v3, v15
    v_lshlrev_b32 v14, 7, v14
    s_lshl_b32 s60, s58, 13
    s_add_u32 s60, s60, 81920
    v_add_u32 v14, s60, v14
    v_lshlrev_b32 v4, 4, v3
    v_add_u32 v144, v14, v4
    v_xor_b32 v3, 4, v3
    v_lshlrev_b32 v4, 4, v3
    v_add_u32 v145, v14, v4
    v_and_b32 v3, 15, v2
    v_lshrrev_b32 v4, 4, v2
    v_lshrrev_b32 v5, 2, v3
    v_and_b32 v6, 3, v3
    v_lshlrev_b32 v7, 3, v4
    v_add_u32 v7, v7, v5
    v_and_b32 v8, 1, v4
    v_lshlrev_b32 v8, 2, v8
    v_or_b32 v8, v8, v5
    v_lshlrev_b32 v7, 8, v7
    v_lshlrev_b32 v6, 3, v6
    v_add_u32 v7, v7, v6
    s_lshl_b32 s60, s59, 2
    s_lshl_b32 s61, s58, 1
    s_xor_b32 s62, s61, 0
    s_add_u32 s62, s62, s60
    v_xor_b32 v6, s62, v8
    v_lshlrev_b32 v6, 5, v6
    v_add_u32 v146, v6, v7
    s_xor_b32 s62, s61, 1
    s_add_u32 s62, s62, s60
    v_xor_b32 v6, s62, v8
    v_lshlrev_b32 v6, 5, v6
    v_add_u32 v147, v6, v7
    s_xor_b32 s62, s61, 2
    s_add_u32 s62, s62, s60
    v_xor_b32 v6, s62, v8
    v_lshlrev_b32 v6, 5, v6
    v_add_u32 v148, v6, v7
    s_xor_b32 s62, s61, 3
    s_add_u32 s62, s62, s60
    v_xor_b32 v6, s62, v8
    v_lshlrev_b32 v6, 5, v6
    v_add_u32 v149, v6, v7
    v_lshrrev_b32 v180, 4, v2
    v_lshlrev_b32 v180, 11, v180
    v_and_b32 v4, 15, v2
    v_lshlrev_b32 v4, 4, v4
    v_add_u32 v180, v180, v4
    s_lshl_b32 s74, s57, 16
    s_lshl_b32 s60, s56, 10
    s_add_u32 s74, s74, s60
    s_lshl_b32 s60, s58, 9
    s_add_u32 s74, s74, s60
    s_lshl_b32 s75, s59, 2
    s_lshl_b32 s76, s58, 1
    s_mul_i32 s77, s52, 0x100000
    s_add_u32 s77, s77, 0x100000
    s_mul_i32 s78, s52, 0x100000
    s_add_u32 s78, s78, 0x100000
    s_xor_b32 s60, s76, 0
    s_add_u32 s60, s60, s75
    s_lshl_b32 s60, s60, 13
    s_add_u32 s60, s60, s74
    s_add_u32 s68, s60, s77
    s_add_u32 s80, s60, s78
    s_xor_b32 s60, s76, 1
    s_add_u32 s60, s60, s75
    s_lshl_b32 s60, s60, 13
    s_add_u32 s60, s60, s74
    s_add_u32 s69, s60, s77
    s_add_u32 s81, s60, s78
    s_xor_b32 s60, s76, 2
    s_add_u32 s60, s60, s75
    s_lshl_b32 s60, s60, 13
    s_add_u32 s60, s60, s74
    s_add_u32 s70, s60, s77
    s_add_u32 s82, s60, s78
    s_xor_b32 s60, s76, 3
    s_add_u32 s60, s60, s75
    s_lshl_b32 s60, s60, 13
    s_add_u32 s60, s60, s74
    s_add_u32 s71, s60, s77
    s_add_u32 s83, s60, s78
    v_mov_b32 v16, 0
    v_mov_b32 v17, 0
    v_mov_b32 v18, 0
    v_mov_b32 v19, 0
    v_mov_b32 v20, 0
    v_mov_b32 v21, 0
    v_mov_b32 v22, 0
    v_mov_b32 v23, 0
    v_mov_b32 v24, 0
    v_mov_b32 v25, 0
    v_mov_b32 v26, 0
    v_mov_b32 v27, 0
    v_mov_b32 v28, 0
    v_mov_b32 v29, 0
    v_mov_b32 v30, 0
    v_mov_b32 v31, 0
    v_mov_b32 v32, 0
    v_mov_b32 v33, 0
    v_mov_b32 v34, 0
    v_mov_b32 v35, 0
    v_mov_b32 v36, 0
    v_mov_b32 v37, 0
    v_mov_b32 v38, 0
    v_mov_b32 v39, 0
    v_mov_b32 v40, 0
    v_mov_b32 v41, 0
    v_mov_b32 v42, 0
    v_mov_b32 v43, 0
    v_mov_b32 v44, 0
    v_mov_b32 v45, 0
    v_mov_b32 v46, 0
    v_mov_b32 v47, 0
    v_mov_b32 v48, 0
    v_mov_b32 v49, 0
    v_mov_b32 v50, 0
    v_mov_b32 v51, 0
    v_mov_b32 v52, 0
    v_mov_b32 v53, 0
    v_mov_b32 v54, 0
    v_mov_b32 v55, 0
    v_mov_b32 v56, 0
    v_mov_b32 v57, 0
    v_mov_b32 v58, 0
    v_mov_b32 v59, 0
    v_mov_b32 v60, 0
    v_mov_b32 v61, 0
    v_mov_b32 v62, 0
    v_mov_b32 v63, 0
    v_mov_b32 v64, 0
    v_mov_b32 v65, 0
    v_mov_b32 v66, 0
    v_mov_b32 v67, 0
    v_mov_b32 v68, 0
    v_mov_b32 v69, 0
    v_mov_b32 v70, 0
    v_mov_b32 v71, 0
    v_mov_b32 v72, 0
    v_mov_b32 v73, 0
    v_mov_b32 v74, 0
    v_mov_b32 v75, 0
    v_mov_b32 v76, 0
    v_mov_b32 v77, 0
    v_mov_b32 v78, 0
    v_mov_b32 v79, 0
    v_mov_b32 v152, 0
    v_mov_b32 v153, 0
    v_mov_b32 v154, 0
    v_mov_b32 v155, 0
    v_mov_b32 v156, 0
    v_mov_b32 v157, 0
    v_mov_b32 v158, 0
    v_mov_b32 v159, 0
    v_mov_b32 v160, 0x3f803f80
    v_mov_b32 v161, 0x3f803f80
    v_mov_b32 v162, 0x3f803f80
    v_mov_b32 v163, 0x3f803f80
    v_mov_b32 v164, 0
    v_mov_b32 v165, 0
    v_mov_b32 v166, 0
    v_mov_b32 v167, 0
    v_mov_b32 v168, 0
    v_mov_b32 v169, 0
    v_mov_b32 v170, 0
    v_mov_b32 v171, 0
    v_mov_b32 v172, 0
    v_mov_b32 v173, 0
    v_mov_b32 v174, 0
    v_mov_b32 v175, 0
    v_mov_b32 v176, 0
    v_mov_b32 v177, 0
    v_mov_b32 v178, 0
    v_mov_b32 v179, 0
    s_mov_b32 s60, 0
    s_mov_b32 s62, 0
    s_mov_b32 s64, 0
    s_barrier
    ds_read_b128 v[80:83], v144 offset:0
    ds_read_b64_tr_b16 v[96:97], v146 offset:0
    ds_read_b64_tr_b16 v[98:99], v146 offset:1024
    ds_read_b128 v[84:87], v144 offset:2048
    ds_read_b64_tr_b16 v[100:101], v147 offset:0
    ds_read_b64_tr_b16 v[102:103], v147 offset:1024
    ds_read_b128 v[88:91], v144 offset:4096
    ds_read_b64_tr_b16 v[104:105], v148 offset:0
    ds_read_b64_tr_b16 v[106:107], v148 offset:1024
    ds_read_b128 v[92:95], v144 offset:6144
    ds_read_b64_tr_b16 v[108:109], v149 offset:0
    ds_read_b64_tr_b16 v[110:111], v149 offset:1024
    s_cmp_lg_u32 s59, 0
    s_cbranch_scc1 p1_v1_2
p1_loop_3:
    s_waitcnt lgkmcnt(0)
    v_mfma_f32_16x16x32_bf16 v[16:19], v[96:99], v[80:83], v[16:19]
    ds_read_b128 v[112:115], v145 offset:0
    s_add_u32 s60, s60, 1
    s_cmp_eq_u32 s60, 5
    v_mfma_f32_16x16x32_bf16 v[32:35], v[100:103], v[80:83], v[32:35]
    ds_read_b64_tr_b16 v[128:129], v146 offset:8192
    s_mov_b32 s61, 16384
    s_cselect_b32 s61, 0xffff0000, s61
    v_mfma_f32_16x16x32_bf16 v[48:51], v[104:107], v[80:83], v[48:51]
    ds_read_b64_tr_b16 v[130:131], v146 offset:9216
    s_cselect_b32 s60, 0, s60
    s_add_u32 s64, s64, 1
    v_mfma_f32_16x16x32_bf16 v[64:67], v[108:111], v[80:83], v[64:67]
    ds_read_b128 v[116:119], v145 offset:2048
    s_cmp_eq_u32 s64, 4
    s_mov_b32 s65, 16384
    v_mfma_f32_16x16x32_bf16 v[164:167], v[160:163], v[80:83], v[164:167]
    v_mfma_f32_16x16x32_bf16 v[20:23], v[96:99], v[84:87], v[20:23]
    ds_read_b64_tr_b16 v[132:133], v147 offset:8192
    s_cselect_b32 s65, 0xffff4000, s65
    s_cselect_b32 s64, 0, s64
    v_mfma_f32_16x16x32_bf16 v[36:39], v[100:103], v[84:87], v[36:39]
    ds_read_b64_tr_b16 v[134:135], v147 offset:9216
    v_mfma_f32_16x16x32_bf16 v[172:175], v[80:83], v[80:83], v[172:175]
    v_mfma_f32_16x16x32_bf16 v[52:55], v[104:107], v[84:87], v[52:55]
    ds_read_b128 v[120:123], v145 offset:4096
    v_mfma_f32_16x16x32_bf16 v[68:71], v[108:111], v[84:87], v[68:71]
    ds_read_b64_tr_b16 v[136:137], v148 offset:8192
    v_mfma_f32_16x16x32_bf16 v[24:27], v[96:99], v[88:91], v[24:27]
    ds_read_b64_tr_b16 v[138:139], v148 offset:9216
    v_mfma_f32_16x16x32_bf16 v[40:43], v[100:103], v[88:91], v[40:43]
    ds_read_b128 v[124:127], v145 offset:6144
    v_mfma_f32_16x16x32_bf16 v[168:171], v[160:163], v[84:87], v[168:171]
    v_mfma_f32_16x16x32_bf16 v[56:59], v[104:107], v[88:91], v[56:59]
    ds_read_b64_tr_b16 v[140:141], v149 offset:8192
    v_mfma_f32_16x16x32_bf16 v[72:75], v[108:111], v[88:91], v[72:75]
    ds_read_b64_tr_b16 v[142:143], v149 offset:9216
    v_mfma_f32_16x16x32_bf16 v[176:179], v[84:87], v[84:87], v[176:179]
    v_mfma_f32_16x16x32_bf16 v[28:31], v[96:99], v[92:95], v[28:31]
    v_add_u32 v144, s65, v144
    v_add_u32 v145, s65, v145
    v_add_u32 v146, s61, v146
    v_mfma_f32_16x16x32_bf16 v[44:47], v[100:103], v[92:95], v[44:47]
    v_add_u32 v147, s61, v147
    v_add_u32 v148, s61, v148
    v_add_u32 v149, s61, v149
    v_mfma_f32_16x16x32_bf16 v[152:155], v[96:99], v[160:163], v[152:155]
    v_mfma_f32_16x16x32_bf16 v[60:63], v[104:107], v[92:95], v[60:63]
    s_add_u32 s62, s62, 1
    v_mfma_f32_16x16x32_bf16 v[76:79], v[108:111], v[92:95], v[76:79]
    v_mfma_f32_16x16x32_bf16 v[156:159], v[100:103], v[160:163], v[156:159]
    s_cmp_eq_u32 s62, 10
    s_waitcnt lgkmcnt(0)
    s_cbranch_scc1 p1_last_4
    v_mfma_f32_16x16x32_bf16 v[16:19], v[128:131], v[112:115], v[16:19]
    ds_read_b128 v[80:83], v144 offset:0
    v_mfma_f32_16x16x32_bf16 v[32:35], v[132:135], v[112:115], v[32:35]
    ds_read_b64_tr_b16 v[96:97], v146 offset:0
    v_mfma_f32_16x16x32_bf16 v[48:51], v[136:139], v[112:115], v[48:51]
    ds_read_b64_tr_b16 v[98:99], v146 offset:1024
    v_mfma_f32_16x16x32_bf16 v[64:67], v[140:143], v[112:115], v[64:67]
    ds_read_b128 v[84:87], v144 offset:2048
    v_mfma_f32_16x16x32_bf16 v[164:167], v[160:163], v[112:115], v[164:167]
    v_mfma_f32_16x16x32_bf16 v[20:23], v[128:131], v[116:119], v[20:23]
    ds_read_b64_tr_b16 v[100:101], v147 offset:0
    v_mfma_f32_16x16x32_bf16 v[36:39], v[132:135], v[116:119], v[36:39]
    ds_read_b64_tr_b16 v[102:103], v147 offset:1024
    v_mfma_f32_16x16x32_bf16 v[172:175], v[112:115], v[112:115], v[172:175]
    v_mfma_f32_16x16x32_bf16 v[52:55], v[136:139], v[116:119], v[52:55]
    ds_read_b128 v[88:91], v144 offset:4096
    v_mfma_f32_16x16x32_bf16 v[68:71], v[140:143], v[116:119], v[68:71]
    ds_read_b64_tr_b16 v[104:105], v148 offset:0
    v_mfma_f32_16x16x32_bf16 v[24:27], v[128:131], v[120:123], v[24:27]
    ds_read_b64_tr_b16 v[106:107], v148 offset:1024
    v_mfma_f32_16x16x32_bf16 v[40:43], v[132:135], v[120:123], v[40:43]
    ds_read_b128 v[92:95], v144 offset:6144
    v_mfma_f32_16x16x32_bf16 v[168:171], v[160:163], v[116:119], v[168:171]
    v_mfma_f32_16x16x32_bf16 v[56:59], v[136:139], v[120:123], v[56:59]
    ds_read_b64_tr_b16 v[108:109], v149 offset:0
    v_mfma_f32_16x16x32_bf16 v[72:75], v[140:143], v[120:123], v[72:75]
    ds_read_b64_tr_b16 v[110:111], v149 offset:1024
    v_mfma_f32_16x16x32_bf16 v[176:179], v[116:119], v[116:119], v[176:179]
    v_mfma_f32_16x16x32_bf16 v[28:31], v[128:131], v[124:127], v[28:31]
    v_mfma_f32_16x16x32_bf16 v[44:47], v[132:135], v[124:127], v[44:47]
    v_mfma_f32_16x16x32_bf16 v[152:155], v[128:131], v[160:163], v[152:155]
    v_mfma_f32_16x16x32_bf16 v[60:63], v[136:139], v[124:127], v[60:63]
    v_mfma_f32_16x16x32_bf16 v[76:79], v[140:143], v[124:127], v[76:79]
    v_mfma_f32_16x16x32_bf16 v[156:159], v[132:135], v[160:163], v[156:159]
    s_barrier
    s_branch p1_loop_3
p1_last_4:
    v_mfma_f32_16x16x32_bf16 v[16:19], v[128:131], v[112:115], v[16:19]
    v_mfma_f32_16x16x32_bf16 v[32:35], v[132:135], v[112:115], v[32:35]
    v_mfma_f32_16x16x32_bf16 v[48:51], v[136:139], v[112:115], v[48:51]
    v_mfma_f32_16x16x32_bf16 v[64:67], v[140:143], v[112:115], v[64:67]
    v_mfma_f32_16x16x32_bf16 v[164:167], v[160:163], v[112:115], v[164:167]
    v_mfma_f32_16x16x32_bf16 v[20:23], v[128:131], v[116:119], v[20:23]
    v_mfma_f32_16x16x32_bf16 v[36:39], v[132:135], v[116:119], v[36:39]
    v_mfma_f32_16x16x32_bf16 v[172:175], v[112:115], v[112:115], v[172:175]
    v_mfma_f32_16x16x32_bf16 v[52:55], v[136:139], v[116:119], v[52:55]
    v_mfma_f32_16x16x32_bf16 v[68:71], v[140:143], v[116:119], v[68:71]
    v_mfma_f32_16x16x32_bf16 v[24:27], v[128:131], v[120:123], v[24:27]
    v_mfma_f32_16x16x32_bf16 v[40:43], v[132:135], v[120:123], v[40:43]
    v_mfma_f32_16x16x32_bf16 v[168:171], v[160:163], v[116:119], v[168:171]
    v_mfma_f32_16x16x32_bf16 v[56:59], v[136:139], v[120:123], v[56:59]
    v_mfma_f32_16x16x32_bf16 v[72:75], v[140:143], v[120:123], v[72:75]
    v_mfma_f32_16x16x32_bf16 v[176:179], v[116:119], v[116:119], v[176:179]
    v_mfma_f32_16x16x32_bf16 v[28:31], v[128:131], v[124:127], v[28:31]
    v_mfma_f32_16x16x32_bf16 v[44:47], v[132:135], v[124:127], v[44:47]
    v_mfma_f32_16x16x32_bf16 v[152:155], v[128:131], v[160:163], v[152:155]
    v_mfma_f32_16x16x32_bf16 v[60:63], v[136:139], v[124:127], v[60:63]
    v_mfma_f32_16x16x32_bf16 v[76:79], v[140:143], v[124:127], v[76:79]
    v_mfma_f32_16x16x32_bf16 v[156:159], v[132:135], v[160:163], v[156:159]
    s_branch p1_end_1
p1_v1_2:
p1_loop_5:
    s_waitcnt lgkmcnt(0)
    v_mfma_f32_16x16x32_bf16 v[16:19], v[96:99], v[80:83], v[16:19]
    ds_read_b128 v[112:115], v145 offset:0
    s_add_u32 s60, s60, 1
    s_cmp_eq_u32 s60, 5
    v_mfma_f32_16x16x32_bf16 v[32:35], v[100:103], v[80:83], v[32:35]
    ds_read_b64_tr_b16 v[128:129], v146 offset:8192
    s_mov_b32 s61, 16384
    s_cselect_b32 s61, 0xffff0000, s61
    v_mfma_f32_16x16x32_bf16 v[48:51], v[104:107], v[80:83], v[48:51]
    ds_read_b64_tr_b16 v[130:131], v146 offset:9216
    s_cselect_b32 s60, 0, s60
    s_add_u32 s64, s64, 1
    v_mfma_f32_16x16x32_bf16 v[64:67], v[108:111], v[80:83], v[64:67]
    ds_read_b128 v[116:119], v145 offset:2048
    s_cmp_eq_u32 s64, 4
    s_mov_b32 s65, 16384
    v_mfma_f32_16x16x32_bf16 v[164:167], v[160:163], v[88:91], v[164:167]
    v_mfma_f32_16x16x32_bf16 v[20:23], v[96:99], v[84:87], v[20:23]
    ds_read_b64_tr_b16 v[132:133], v147 offset:8192
    s_cselect_b32 s65, 0xffff4000, s65
    s_cselect_b32 s64, 0, s64
    v_mfma_f32_16x16x32_bf16 v[36:39], v[100:103], v[84:87], v[36:39]
    ds_read_b64_tr_b16 v[134:135], v147 offset:9216
    v_mfma_f32_16x16x32_bf16 v[172:175], v[88:91], v[88:91], v[172:175]
    v_mfma_f32_16x16x32_bf16 v[52:55], v[104:107], v[84:87], v[52:55]
    ds_read_b128 v[120:123], v145 offset:4096
    v_mfma_f32_16x16x32_bf16 v[68:71], v[108:111], v[84:87], v[68:71]
    ds_read_b64_tr_b16 v[136:137], v148 offset:8192
    v_mfma_f32_16x16x32_bf16 v[24:27], v[96:99], v[88:91], v[24:27]
    ds_read_b64_tr_b16 v[138:139], v148 offset:9216
    v_mfma_f32_16x16x32_bf16 v[40:43], v[100:103], v[88:91], v[40:43]
    ds_read_b128 v[124:127], v145 offset:6144
    v_mfma_f32_16x16x32_bf16 v[168:171], v[160:163], v[92:95], v[168:171]
    v_mfma_f32_16x16x32_bf16 v[56:59], v[104:107], v[88:91], v[56:59]
    ds_read_b64_tr_b16 v[140:141], v149 offset:8192
    v_mfma_f32_16x16x32_bf16 v[72:75], v[108:111], v[88:91], v[72:75]
    ds_read_b64_tr_b16 v[142:143], v149 offset:9216
    v_mfma_f32_16x16x32_bf16 v[176:179], v[92:95], v[92:95], v[176:179]
    v_mfma_f32_16x16x32_bf16 v[28:31], v[96:99], v[92:95], v[28:31]
    v_add_u32 v144, s65, v144
    v_add_u32 v145, s65, v145
    v_add_u32 v146, s61, v146
    v_mfma_f32_16x16x32_bf16 v[44:47], v[100:103], v[92:95], v[44:47]
    v_add_u32 v147, s61, v147
    v_add_u32 v148, s61, v148
    v_add_u32 v149, s61, v149
    v_mfma_f32_16x16x32_bf16 v[152:155], v[96:99], v[160:163], v[152:155]
    v_mfma_f32_16x16x32_bf16 v[60:63], v[104:107], v[92:95], v[60:63]
    s_add_u32 s62, s62, 1
    v_mfma_f32_16x16x32_bf16 v[76:79], v[108:111], v[92:95], v[76:79]
    v_mfma_f32_16x16x32_bf16 v[156:159], v[100:103], v[160:163], v[156:159]
    s_cmp_eq_u32 s62, 10
    s_waitcnt lgkmcnt(0)
    s_cbranch_scc1 p1_last_6
    v_mfma_f32_16x16x32_bf16 v[16:19], v[128:131], v[112:115], v[16:19]
    ds_read_b128 v[80:83], v144 offset:0
    v_mfma_f32_16x16x32_bf16 v[32:35], v[132:135], v[112:115], v[32:35]
    ds_read_b64_tr_b16 v[96:97], v146 offset:0
    v_mfma_f32_16x16x32_bf16 v[48:51], v[136:139], v[112:115], v[48:51]
    ds_read_b64_tr_b16 v[98:99], v146 offset:1024
    v_mfma_f32_16x16x32_bf16 v[64:67], v[140:143], v[112:115], v[64:67]
    ds_read_b128 v[84:87], v144 offset:2048
    v_mfma_f32_16x16x32_bf16 v[164:167], v[160:163], v[120:123], v[164:167]
    v_mfma_f32_16x16x32_bf16 v[20:23], v[128:131], v[116:119], v[20:23]
    ds_read_b64_tr_b16 v[100:101], v147 offset:0
    v_mfma_f32_16x16x32_bf16 v[36:39], v[132:135], v[116:119], v[36:39]
    ds_read_b64_tr_b16 v[102:103], v147 offset:1024
    v_mfma_f32_16x16x32_bf16 v[172:175], v[120:123], v[120:123], v[172:175]
    v_mfma_f32_16x16x32_bf16 v[52:55], v[136:139], v[116:119], v[52:55]
    ds_read_b128 v[88:91], v144 offset:4096
    v_mfma_f32_16x16x32_bf16 v[68:71], v[140:143], v[116:119], v[68:71]
    ds_read_b64_tr_b16 v[104:105], v148 offset:0
    v_mfma_f32_16x16x32_bf16 v[24:27], v[128:131], v[120:123], v[24:27]
    ds_read_b64_tr_b16 v[106:107], v148 offset:1024
    v_mfma_f32_16x16x32_bf16 v[40:43], v[132:135], v[120:123], v[40:43]
    ds_read_b128 v[92:95], v144 offset:6144
    v_mfma_f32_16x16x32_bf16 v[168:171], v[160:163], v[124:127], v[168:171]
    v_mfma_f32_16x16x32_bf16 v[56:59], v[136:139], v[120:123], v[56:59]
    ds_read_b64_tr_b16 v[108:109], v149 offset:0
    v_mfma_f32_16x16x32_bf16 v[72:75], v[140:143], v[120:123], v[72:75]
    ds_read_b64_tr_b16 v[110:111], v149 offset:1024
    v_mfma_f32_16x16x32_bf16 v[176:179], v[124:127], v[124:127], v[176:179]
    v_mfma_f32_16x16x32_bf16 v[28:31], v[128:131], v[124:127], v[28:31]
    v_mfma_f32_16x16x32_bf16 v[44:47], v[132:135], v[124:127], v[44:47]
    v_mfma_f32_16x16x32_bf16 v[152:155], v[128:131], v[160:163], v[152:155]
    v_mfma_f32_16x16x32_bf16 v[60:63], v[136:139], v[124:127], v[60:63]
    v_mfma_f32_16x16x32_bf16 v[76:79], v[140:143], v[124:127], v[76:79]
    v_mfma_f32_16x16x32_bf16 v[156:159], v[132:135], v[160:163], v[156:159]
    s_barrier
    s_branch p1_loop_5
p1_last_6:
    v_mfma_f32_16x16x32_bf16 v[16:19], v[128:131], v[112:115], v[16:19]
    v_mfma_f32_16x16x32_bf16 v[32:35], v[132:135], v[112:115], v[32:35]
    v_mfma_f32_16x16x32_bf16 v[48:51], v[136:139], v[112:115], v[48:51]
    v_mfma_f32_16x16x32_bf16 v[64:67], v[140:143], v[112:115], v[64:67]
    v_mfma_f32_16x16x32_bf16 v[164:167], v[160:163], v[120:123], v[164:167]
    v_mfma_f32_16x16x32_bf16 v[20:23], v[128:131], v[116:119], v[20:23]
    v_mfma_f32_16x16x32_bf16 v[36:39], v[132:135], v[116:119], v[36:39]
    v_mfma_f32_16x16x32_bf16 v[172:175], v[120:123], v[120:123], v[172:175]
    v_mfma_f32_16x16x32_bf16 v[52:55], v[136:139], v[116:119], v[52:55]
    v_mfma_f32_16x16x32_bf16 v[68:71], v[140:143], v[116:119], v[68:71]
    v_mfma_f32_16x16x32_bf16 v[24:27], v[128:131], v[120:123], v[24:27]
    v_mfma_f32_16x16x32_bf16 v[40:43], v[132:135], v[120:123], v[40:43]
    v_mfma_f32_16x16x32_bf16 v[168:171], v[160:163], v[124:127], v[168:171]
    v_mfma_f32_16x16x32_bf16 v[56:59], v[136:139], v[120:123], v[56:59]
    v_mfma_f32_16x16x32_bf16 v[72:75], v[140:143], v[120:123], v[72:75]
    v_mfma_f32_16x16x32_bf16 v[176:179], v[124:127], v[124:127], v[176:179]
    v_mfma_f32_16x16x32_bf16 v[28:31], v[128:131], v[124:127], v[28:31]
    v_mfma_f32_16x16x32_bf16 v[44:47], v[132:135], v[124:127], v[44:47]
    v_mfma_f32_16x16x32_bf16 v[152:155], v[128:131], v[160:163], v[152:155]
    v_mfma_f32_16x16x32_bf16 v[60:63], v[136:139], v[124:127], v[60:63]
    v_mfma_f32_16x16x32_bf16 v[76:79], v[140:143], v[124:127], v[76:79]
    v_mfma_f32_16x16x32_bf16 v[156:159], v[132:135], v[160:163], v[156:159]
p1_end_1:
    s_barrier
    v_and_b32 v3, 15, v2
    v_lshrrev_b32 v4, 4, v2
    v_lshrrev_b32 v5, 2, v3
    v_and_b32 v6, 3, v3
    v_cmp_eq_u32 s[66:67], v4, v5
    v_cmp_eq_u32 vcc, 1, v6
    s_nop 1
    v_cndmask_b32 v7, v172, v173, vcc
    v_cmp_eq_u32 vcc, 2, v6
    s_nop 1
    v_cndmask_b32 v7, v7, v174, vcc
    v_cmp_eq_u32 vcc, 3, v6
    s_nop 1
    v_cndmask_b32 v7, v7, v175, vcc
    v_cndmask_b32_e64 v7, 0, v7, s[66:67]
    v_mov_b32 v8, v7
    s_nop 1
    v_permlane32_swap_b32 v7, v8
    v_add_f32 v7, v7, v8
    v_mov_b32 v8, v7
    s_nop 1
    v_permlane16_swap_b32 v7, v8
    v_add_f32 v7, v7, v8
    v_mov_b32 v10, v164
    v_mov_b32 v11, v7
    v_mul_f32 v10, 0x3acccccd, v10
    v_mul_f32 v11, 0x3acccccd, v11
    v_fma_f32 v11, -v10, v10, v11
    v_max_f32 v11, 0, v11
    v_add_f32 v11, 0x3727c5ac, v11
    v_rsq_f32 v11, v11
    v_cmp_eq_u32 vcc, 1, v6
    s_nop 1
    v_cndmask_b32 v7, v176, v177, vcc
    v_cmp_eq_u32 vcc, 2, v6
    s_nop 1
    v_cndmask_b32 v7, v7, v178, vcc
    v_cmp_eq_u32 vcc, 3, v6
    s_nop 1
    v_cndmask_b32 v7, v7, v179, vcc
    v_cndmask_b32_e64 v7, 0, v7, s[66:67]
    v_mov_b32 v8, v7
    s_nop 1
    v_permlane32_swap_b32 v7, v8
    v_add_f32 v7, v7, v8
    v_mov_b32 v8, v7
    s_nop 1
    v_permlane16_swap_b32 v7, v8
    v_add_f32 v7, v7, v8
    v_mov_b32 v12, v168
    v_mov_b32 v13, v7
    v_mul_f32 v12, 0x3acccccd, v12
    v_mul_f32 v13, 0x3acccccd, v13
    v_fma_f32 v13, -v12, v12, v13
    v_max_f32 v13, 0, v13
    v_add_f32 v13, 0x3727c5ac, v13
    v_rsq_f32 v13, v13
    s_lshl_b32 s60, s58, 9
    s_lshl_b32 s61, s59, 8
    s_add_u32 s60, s60, s61
    s_add_u32 s60, s60, 160256
    v_lshlrev_b32 v3, 3, v3
    v_add_u32 v3, s60, v3
    s_mov_b64 s[66:67], exec
    s_mov_b64 exec, 0xffff
    ds_write_b64 v3, v[10:11]
    ds_write_b64 v3, v[12:13] offset:128
    s_mov_b64 exec, s[66:67]
    v_lshrrev_b32 v3, 4, v2
    v_lshlrev_b32 v3, 4, v3
    s_lshl_b32 s60, s59, 2
    s_lshl_b32 s61, s58, 1
    s_mov_b64 s[66:67], exec
    s_xor_b32 s62, s61, 0
    s_add_u32 s62, s62, s60
    s_lshl_b32 s62, s62, 6
    s_add_u32 s62, s62, 161280
    v_add_u32 v4, s62, v3
    s_xor_b32 s62, s61, 1
    s_add_u32 s62, s62, s60
    s_lshl_b32 s62, s62, 6
    s_add_u32 s62, s62, 161280
    v_add_u32 v5, s62, v3
    s_mov_b32 exec_lo, 0x00010001
    s_mov_b32 exec_hi, 0x00010001
    ds_write_b128 v4, v[152:155]
    ds_write_b128 v5, v[156:159]
    s_mov_b64 exec, s[66:67]
    s_waitcnt lgkmcnt(0)
    s_waitcnt lgkmcnt(0)
    s_barrier
    v_lshrrev_b32 v3, 4, v2
    v_lshlrev_b32 v3, 4, v3
    s_lshl_b32 s60, s59, 2
    s_lshl_b32 s61, s58, 1
    s_xor_b32 s62, s61, 0
    s_add_u32 s62, s62, s60
    s_lshl_b32 s62, s62, 6
    s_add_u32 s62, s62, 161280
    v_add_u32 v4, s62, v3
    ds_read_b128 v[80:83], v4
    s_xor_b32 s62, s61, 1
    s_add_u32 s62, s62, s60
    s_lshl_b32 s62, s62, 6
    s_add_u32 s62, s62, 161280
    v_add_u32 v4, s62, v3
    ds_read_b128 v[84:87], v4
    s_xor_b32 s62, s61, 2
    s_add_u32 s62, s62, s60
    s_lshl_b32 s62, s62, 6
    s_add_u32 s62, s62, 161280
    v_add_u32 v4, s62, v3
    ds_read_b128 v[88:91], v4
    s_xor_b32 s62, s61, 3
    s_add_u32 s62, s62, s60
    s_lshl_b32 s62, s62, 6
    s_add_u32 s62, s62, 161280
    v_add_u32 v4, s62, v3
    ds_read_b128 v[92:95], v4
    v_and_b32 v3, 15, v2
    v_lshlrev_b32 v3, 3, v3
    s_lshl_b32 s60, s58, 9
    s_add_u32 s60, s60, 160256
    v_add_u32 v3, s60, v3
    ds_read_b64 v[96:97], v3 offset:0
    ds_read_b64 v[98:99], v3 offset:128
    ds_read_b64 v[100:101], v3 offset:256
    ds_read_b64 v[102:103], v3 offset:384
    s_waitcnt lgkmcnt(0)
    s_cmp_lt_u32 s57, 5
    s_cselect_b32 s60, 0x3ea52b5c, 0x3f800000
    v_mul_f32 v97, s60, v97
    v_mul_f32 v99, s60, v99
    v_mul_f32 v101, s60, v101
    v_mul_f32 v103, s60, v103
    v_pk_fma_f32 v[16:17], v[96:97], v[80:81], v[16:17] op_sel_hi:[0,1,1] neg_lo:[1,0,0] neg_hi:[1,0,0]
    v_pk_fma_f32 v[18:19], v[96:97], v[82:83], v[18:19] op_sel_hi:[0,1,1] neg_lo:[1,0,0] neg_hi:[1,0,0]
    v_pk_fma_f32 v[20:21], v[98:99], v[80:81], v[20:21] op_sel_hi:[0,1,1] neg_lo:[1,0,0] neg_hi:[1,0,0]
    v_pk_fma_f32 v[22:23], v[98:99], v[82:83], v[22:23] op_sel_hi:[0,1,1] neg_lo:[1,0,0] neg_hi:[1,0,0]
    v_pk_mul_f32 v[16:17], v[16:17], v[96:97] op_sel:[0,1] op_sel_hi:[1,1]
    v_pk_mul_f32 v[18:19], v[18:19], v[96:97] op_sel:[0,1] op_sel_hi:[1,1]
    v_pk_mul_f32 v[20:21], v[20:21], v[98:99] op_sel:[0,1] op_sel_hi:[1,1]
    v_pk_mul_f32 v[22:23], v[22:23], v[98:99] op_sel:[0,1] op_sel_hi:[1,1]
    v_cvt_pk_bf16_f32 v112, v16, v17
    v_cvt_pk_bf16_f32 v113, v18, v19
    v_cvt_pk_bf16_f32 v114, v20, v21
    v_cvt_pk_bf16_f32 v115, v22, v23
    s_cmp_ge_u32 s57, 5
    s_cbranch_scc1 st_7
    buffer_store_dwordx4 v[112:115], v180, s[36:39], s68 offen offset:0
    s_branch st_8
st_7:
    buffer_store_dwordx4 v[112:115], v180, s[36:39], s80 offen offset:0 sc0 sc1
st_8:
    v_pk_fma_f32 v[24:25], v[100:101], v[80:81], v[24:25] op_sel_hi:[0,1,1] neg_lo:[1,0,0] neg_hi:[1,0,0]
    v_pk_fma_f32 v[26:27], v[100:101], v[82:83], v[26:27] op_sel_hi:[0,1,1] neg_lo:[1,0,0] neg_hi:[1,0,0]
    v_pk_fma_f32 v[28:29], v[102:103], v[80:81], v[28:29] op_sel_hi:[0,1,1] neg_lo:[1,0,0] neg_hi:[1,0,0]
    v_pk_fma_f32 v[30:31], v[102:103], v[82:83], v[30:31] op_sel_hi:[0,1,1] neg_lo:[1,0,0] neg_hi:[1,0,0]
    v_pk_mul_f32 v[24:25], v[24:25], v[100:101] op_sel:[0,1] op_sel_hi:[1,1]
    v_pk_mul_f32 v[26:27], v[26:27], v[100:101] op_sel:[0,1] op_sel_hi:[1,1]
    v_pk_mul_f32 v[28:29], v[28:29], v[102:103] op_sel:[0,1] op_sel_hi:[1,1]
    v_pk_mul_f32 v[30:31], v[30:31], v[102:103] op_sel:[0,1] op_sel_hi:[1,1]
    v_cvt_pk_bf16_f32 v116, v24, v25
    v_cvt_pk_bf16_f32 v117, v26, v27
    v_cvt_pk_bf16_f32 v118, v28, v29
    v_cvt_pk_bf16_f32 v119, v30, v31
    s_cmp_ge_u32 s57, 5
    s_cbranch_scc1 st_9
    buffer_store_dwordx4 v[116:119], v180, s[36:39], s68 offen offset:256
    s_branch st_10
st_9:
    buffer_store_dwordx4 v[116:119], v180, s[36:39], s80 offen offset:256 sc0 sc1
st_10:
    v_pk_fma_f32 v[32:33], v[96:97], v[84:85], v[32:33] op_sel_hi:[0,1,1] neg_lo:[1,0,0] neg_hi:[1,0,0]
    v_pk_fma_f32 v[34:35], v[96:97], v[86:87], v[34:35] op_sel_hi:[0,1,1] neg_lo:[1,0,0] neg_hi:[1,0,0]
    v_pk_fma_f32 v[36:37], v[98:99], v[84:85], v[36:37] op_sel_hi:[0,1,1] neg_lo:[1,0,0] neg_hi:[1,0,0]
    v_pk_fma_f32 v[38:39], v[98:99], v[86:87], v[38:39] op_sel_hi:[0,1,1] neg_lo:[1,0,0] neg_hi:[1,0,0]
    v_pk_mul_f32 v[32:33], v[32:33], v[96:97] op_sel:[0,1] op_sel_hi:[1,1]
    v_pk_mul_f32 v[34:35], v[34:35], v[96:97] op_sel:[0,1] op_sel_hi:[1,1]
    v_pk_mul_f32 v[36:37], v[36:37], v[98:99] op_sel:[0,1] op_sel_hi:[1,1]
    v_pk_mul_f32 v[38:39], v[38:39], v[98:99] op_sel:[0,1] op_sel_hi:[1,1]
    v_cvt_pk_bf16_f32 v120, v32, v33
    v_cvt_pk_bf16_f32 v121, v34, v35
    v_cvt_pk_bf16_f32 v122, v36, v37
    v_cvt_pk_bf16_f32 v123, v38, v39
    s_cmp_ge_u32 s57, 5
    s_cbranch_scc1 st_11
    buffer_store_dwordx4 v[120:123], v180, s[36:39], s69 offen offset:0
    s_branch st_12
st_11:
    buffer_store_dwordx4 v[120:123], v180, s[36:39], s81 offen offset:0 sc0 sc1
st_12:
    v_pk_fma_f32 v[40:41], v[100:101], v[84:85], v[40:41] op_sel_hi:[0,1,1] neg_lo:[1,0,0] neg_hi:[1,0,0]
    v_pk_fma_f32 v[42:43], v[100:101], v[86:87], v[42:43] op_sel_hi:[0,1,1] neg_lo:[1,0,0] neg_hi:[1,0,0]
    v_pk_fma_f32 v[44:45], v[102:103], v[84:85], v[44:45] op_sel_hi:[0,1,1] neg_lo:[1,0,0] neg_hi:[1,0,0]
    v_pk_fma_f32 v[46:47], v[102:103], v[86:87], v[46:47] op_sel_hi:[0,1,1] neg_lo:[1,0,0] neg_hi:[1,0,0]
    v_pk_mul_f32 v[40:41], v[40:41], v[100:101] op_sel:[0,1] op_sel_hi:[1,1]
    v_pk_mul_f32 v[42:43], v[42:43], v[100:101] op_sel:[0,1] op_sel_hi:[1,1]
    v_pk_mul_f32 v[44:45], v[44:45], v[102:103] op_sel:[0,1] op_sel_hi:[1,1]
    v_pk_mul_f32 v[46:47], v[46:47], v[102:103] op_sel:[0,1] op_sel_hi:[1,1]
    v_cvt_pk_bf16_f32 v124, v40, v41
    v_cvt_pk_bf16_f32 v125, v42, v43
    v_cvt_pk_bf16_f32 v126, v44, v45
    v_cvt_pk_bf16_f32 v127, v46, v47
    s_cmp_ge_u32 s57, 5
    s_cbranch_scc1 st_13
    buffer_store_dwordx4 v[124:127], v180, s[36:39], s69 offen offset:256
    s_branch st_14
st_13:
    buffer_store_dwordx4 v[124:127], v180, s[36:39], s81 offen offset:256 sc0 sc1
st_14:
    v_pk_fma_f32 v[48:49], v[96:97], v[88:89], v[48:49] op_sel_hi:[0,1,1] neg_lo:[1,0,0] neg_hi:[1,0,0]
    v_pk_fma_f32 v[50:51], v[96:97], v[90:91], v[50:51] op_sel_hi:[0,1,1] neg_lo:[1,0,0] neg_hi:[1,0,0]
    v_pk_fma_f32 v[52:53], v[98:99], v[88:89], v[52:53] op_sel_hi:[0,1,1] neg_lo:[1,0,0] neg_hi:[1,0,0]
    v_pk_fma_f32 v[54:55], v[98:99], v[90:91], v[54:55] op_sel_hi:[0,1,1] neg_lo:[1,0,0] neg_hi:[1,0,0]
    v_pk_mul_f32 v[48:49], v[48:49], v[96:97] op_sel:[0,1] op_sel_hi:[1,1]
    v_pk_mul_f32 v[50:51], v[50:51], v[96:97] op_sel:[0,1] op_sel_hi:[1,1]
    v_pk_mul_f32 v[52:53], v[52:53], v[98:99] op_sel:[0,1] op_sel_hi:[1,1]
    v_pk_mul_f32 v[54:55], v[54:55], v[98:99] op_sel:[0,1] op_sel_hi:[1,1]
    v_cvt_pk_bf16_f32 v128, v48, v49
    v_cvt_pk_bf16_f32 v129, v50, v51
    v_cvt_pk_bf16_f32 v130, v52, v53
    v_cvt_pk_bf16_f32 v131, v54, v55
    s_cmp_ge_u32 s57, 5
    s_cbranch_scc1 st_15
    buffer_store_dwordx4 v[128:131], v180, s[36:39], s70 offen offset:0
    s_branch st_16
st_15:
    buffer_store_dwordx4 v[128:131], v180, s[36:39], s82 offen offset:0 sc0 sc1
st_16:
    v_pk_fma_f32 v[56:57], v[100:101], v[88:89], v[56:57] op_sel_hi:[0,1,1] neg_lo:[1,0,0] neg_hi:[1,0,0]
    v_pk_fma_f32 v[58:59], v[100:101], v[90:91], v[58:59] op_sel_hi:[0,1,1] neg_lo:[1,0,0] neg_hi:[1,0,0]
    v_pk_fma_f32 v[60:61], v[102:103], v[88:89], v[60:61] op_sel_hi:[0,1,1] neg_lo:[1,0,0] neg_hi:[1,0,0]
    v_pk_fma_f32 v[62:63], v[102:103], v[90:91], v[62:63] op_sel_hi:[0,1,1] neg_lo:[1,0,0] neg_hi:[1,0,0]
    v_pk_mul_f32 v[56:57], v[56:57], v[100:101] op_sel:[0,1] op_sel_hi:[1,1]
    v_pk_mul_f32 v[58:59], v[58:59], v[100:101] op_sel:[0,1] op_sel_hi:[1,1]
    v_pk_mul_f32 v[60:61], v[60:61], v[102:103] op_sel:[0,1] op_sel_hi:[1,1]
    v_pk_mul_f32 v[62:63], v[62:63], v[102:103] op_sel:[0,1] op_sel_hi:[1,1]
    v_cvt_pk_bf16_f32 v132, v56, v57
    v_cvt_pk_bf16_f32 v133, v58, v59
    v_cvt_pk_bf16_f32 v134, v60, v61
    v_cvt_pk_bf16_f32 v135, v62, v63
    s_cmp_ge_u32 s57, 5
    s_cbranch_scc1 st_17
    buffer_store_dwordx4 v[132:135], v180, s[36:39], s70 offen offset:256
    s_branch st_18
st_17:
    buffer_store_dwordx4 v[132:135], v180, s[36:39], s82 offen offset:256 sc0 sc1
st_18:
    v_pk_fma_f32 v[64:65], v[96:97], v[92:93], v[64:65] op_sel_hi:[0,1,1] neg_lo:[1,0,0] neg_hi:[1,0,0]
    v_pk_fma_f32 v[66:67], v[96:97], v[94:95], v[66:67] op_sel_hi:[0,1,1] neg_lo:[1,0,0] neg_hi:[1,0,0]
    v_pk_fma_f32 v[68:69], v[98:99], v[92:93], v[68:69] op_sel_hi:[0,1,1] neg_lo:[1,0,0] neg_hi:[1,0,0]
    v_pk_fma_f32 v[70:71], v[98:99], v[94:95], v[70:71] op_sel_hi:[0,1,1] neg_lo:[1,0,0] neg_hi:[1,0,0]
    v_pk_mul_f32 v[64:65], v[64:65], v[96:97] op_sel:[0,1] op_sel_hi:[1,1]
    v_pk_mul_f32 v[66:67], v[66:67], v[96:97] op_sel:[0,1] op_sel_hi:[1,1]
    v_pk_mul_f32 v[68:69], v[68:69], v[98:99] op_sel:[0,1] op_sel_hi:[1,1]
    v_pk_mul_f32 v[70:71], v[70:71], v[98:99] op_sel:[0,1] op_sel_hi:[1,1]
    v_cvt_pk_bf16_f32 v136, v64, v65
    v_cvt_pk_bf16_f32 v137, v66, v67
    v_cvt_pk_bf16_f32 v138, v68, v69
    v_cvt_pk_bf16_f32 v139, v70, v71
    s_cmp_ge_u32 s57, 5
    s_cbranch_scc1 st_19
    buffer_store_dwordx4 v[136:139], v180, s[36:39], s71 offen offset:0
    s_branch st_20
st_19:
    buffer_store_dwordx4 v[136:139], v180, s[36:39], s83 offen offset:0 sc0 sc1
st_20:
    v_pk_fma_f32 v[72:73], v[100:101], v[92:93], v[72:73] op_sel_hi:[0,1,1] neg_lo:[1,0,0] neg_hi:[1,0,0]
    v_pk_fma_f32 v[74:75], v[100:101], v[94:95], v[74:75] op_sel_hi:[0,1,1] neg_lo:[1,0,0] neg_hi:[1,0,0]
    v_pk_fma_f32 v[76:77], v[102:103], v[92:93], v[76:77] op_sel_hi:[0,1,1] neg_lo:[1,0,0] neg_hi:[1,0,0]
    v_pk_fma_f32 v[78:79], v[102:103], v[94:95], v[78:79] op_sel_hi:[0,1,1] neg_lo:[1,0,0] neg_hi:[1,0,0]
    v_pk_mul_f32 v[72:73], v[72:73], v[100:101] op_sel:[0,1] op_sel_hi:[1,1]
    v_pk_mul_f32 v[74:75], v[74:75], v[100:101] op_sel:[0,1] op_sel_hi:[1,1]
    v_pk_mul_f32 v[76:77], v[76:77], v[102:103] op_sel:[0,1] op_sel_hi:[1,1]
    v_pk_mul_f32 v[78:79], v[78:79], v[102:103] op_sel:[0,1] op_sel_hi:[1,1]
    v_cvt_pk_bf16_f32 v140, v72, v73
    v_cvt_pk_bf16_f32 v141, v74, v75
    v_cvt_pk_bf16_f32 v142, v76, v77
    v_cvt_pk_bf16_f32 v143, v78, v79
    s_cmp_ge_u32 s57, 5
    s_cbranch_scc1 st_21
    buffer_store_dwordx4 v[140:143], v180, s[36:39], s71 offen offset:256
    s_branch st_22
st_21:
    buffer_store_dwordx4 v[140:143], v180, s[36:39], s83 offen offset:256 sc0 sc1
st_22:
    s_cmp_lt_u32 s57, 5
    s_cbranch_scc1 p1q_23
    s_waitcnt vmcnt(0)
    s_lshl_b32 s60, s52, 9
    s_sub_u32 s61, s53, 10
    s_lshl_b32 s61, s61, 4
    s_add_u32 s60, s60, s61
    s_lshl_b32 s61, s54, 2
    s_add_u32 s60, s60, s61
    s_add_u32 s60, s60, 0x1000
    v_mov_b32 v3, 1
    v_mov_b32 v4, 0
    s_mov_b64 s[62:63], exec
    s_mov_b64 exec, 1
    buffer_store_dword v3, v4, s[36:39], s60 offen sc0 sc1
    s_mov_b64 exec, s[62:63]
    s_barrier
    s_branch p1d_24
p1q_23:
    s_waitcnt vmcnt(0)
    s_barrier
p1d_24:
    v_lshrrev_b32 v3, 2, v2
    v_lshlrev_b32 v3, 11, v3
    v_and_b32 v4, 3, v2
    v_lshlrev_b32 v4, 7, v4
    v_add_u32 v3, v3, v4
    s_lshl_b32 s60, s59, 15
    s_add_u32 s60, s60, s74
    s_add_u32 s60, s60, s77
    buffer_load_dword v230, v3, s[36:39], s60 offen sc1
    s_branch L_p2
L_p1_np:
    s_cmp_ge_u32 s54, 6
    s_cbranch_scc1 L_p1_sv
    s_sub_u32 s63, s54, 4
    v_lshrrev_b32 v3, 3, v2
    v_and_b32 v4, 7, v2
    v_lshrrev_b32 v5, 4, v2
    s_lshl_b32 s60, s63, 2
    v_add_u32 v5, s60, v5
    v_xor_b32 v4, v4, v5
    v_lshlrev_b32 v4, 4, v4
    s_lshl_b32 s60, s63, 3
    v_add_u32 v3, s60, v3
    s_mov_b32 s61, 1280
    v_mul_lo_u32 v3, v3, s61
    v_add_u32 v16, v3, v4
    v_lshrrev_b32 v3, 4, v2
    s_lshl_b32 s60, s63, 2
    v_or_b32 v4, s60, v3
    v_lshlrev_b32 v4, 1, v4
    v_and_b32 v5, 15, v2
    v_xor_b32 v4, v4, v5
    v_lshlrev_b32 v4, 4, v4
    s_lshl_b32 s60, s63, 3
    v_add_u32 v3, s60, v3
    s_mov_b32 s61, 3840
    v_mul_lo_u32 v3, v3, s61
    v_add_u32 v17, v3, v4
    s_lshl_b32 s64, s52, 8
    s_lshl_b32 s60, s56, 7
    s_add_u32 s64, s64, s60
    s_mul_i32 s64, s64, 1280
    s_lshl_b32 s65, s57, 8
    s_lshl_b32 s66, s63, 10
    s_add_u32 s66, s66, 81920
    s_lshl_b32 s67, s63, 11
    s_mov_b32 s68, 0
    s_mov_b32 s70, 0
    s_add_u32 s60, s70, s66
    s_mov_b32 m0, s60
    s_add_u32 s61, s64, 0
    buffer_load_dwordx4 v16, s[28:31], s61 offen lds
    s_add_u32 s60, s60, 2048
    s_mov_b32 m0, s60
    s_add_u32 s61, s64, 20480
    buffer_load_dwordx4 v16, s[28:31], s61 offen lds
    s_add_u32 s60, s60, 2048
    s_mov_b32 m0, s60
    s_add_u32 s61, s64, 40960
    buffer_load_dwordx4 v16, s[28:31], s61 offen lds
    s_add_u32 s60, s60, 2048
    s_mov_b32 m0, s60
    s_add_u32 s61, s64, 61440
    buffer_load_dwordx4 v16, s[28:31], s61 offen lds
    s_add_u32 s60, s60, 2048
    s_mov_b32 m0, s60
    s_add_u32 s61, s64, 81920
    buffer_load_dwordx4 v16, s[28:31], s61 offen lds
    s_add_u32 s60, s60, 2048
    s_mov_b32 m0, s60
    s_add_u32 s61, s64, 102400
    buffer_load_dwordx4 v16, s[28:31], s61 offen lds
    s_add_u32 s60, s60, 2048
    s_mov_b32 m0, s60
    s_add_u32 s61, s64, 122880
    buffer_load_dwordx4 v16, s[28:31], s61 offen lds
    s_add_u32 s60, s60, 2048
    s_mov_b32 m0, s60
    s_add_u32 s61, s64, 143360
    buffer_load_dwordx4 v16, s[28:31], s61 offen lds
    s_add_u32 s64, s64, 128
    s_add_u32 s70, s70, 16384
    s_cmp_eq_u32 s70, 65536
    s_cselect_b32 s70, 0, s70
    s_add_u32 s60, s68, s67
    s_mov_b32 m0, s60
    s_add_u32 s61, s65, 0
    buffer_load_dwordx4 v17, s[32:35], s61 offen lds
    s_add_u32 s60, s68, s67
    s_add_u32 s60, s60, 1024
    s_mov_b32 m0, s60
    s_add_u32 s61, s65, 15360
    buffer_load_dwordx4 v17, s[32:35], s61 offen lds
    s_add_u32 s60, s68, s67
    s_add_u32 s60, s60, 4096
    s_mov_b32 m0, s60
    s_add_u32 s61, s65, 61440
    buffer_load_dwordx4 v17, s[32:35], s61 offen lds
    s_add_u32 s60, s68, s67
    s_add_u32 s60, s60, 5120
    s_mov_b32 m0, s60
    s_add_u32 s61, s65, 76800
    buffer_load_dwordx4 v17, s[32:35], s61 offen lds
    s_add_u32 s60, s68, s67
    s_add_u32 s60, s60, 8192
    s_mov_b32 m0, s60
    s_add_u32 s61, s65, 122880
    buffer_load_dwordx4 v17, s[32:35], s61 offen lds
    s_add_u32 s60, s68, s67
    s_add_u32 s60, s60, 9216
    s_mov_b32 m0, s60
    s_add_u32 s61, s65, 138240
    buffer_load_dwordx4 v17, s[32:35], s61 offen lds
    s_add_u32 s60, s68, s67
    s_add_u32 s60, s60, 12288
    s_mov_b32 m0, s60
    s_add_u32 s61, s65, 184320
    buffer_load_dwordx4 v17, s[32:35], s61 offen lds
    s_add_u32 s60, s68, s67
    s_add_u32 s60, s60, 13312
    s_mov_b32 m0, s60
    s_add_u32 s61, s65, 199680
    buffer_load_dwordx4 v17, s[32:35], s61 offen lds
    s_add_u32 s65, s65, 245760
    s_add_u32 s68, s68, 16384
    s_cmp_eq_u32 s68, 81920
    s_cselect_b32 s68, 0, s68
    s_add_u32 s60, s70, s66
    s_mov_b32 m0, s60
    s_add_u32 s61, s64, 0
    buffer_load_dwordx4 v16, s[28:31], s61 offen lds
    s_add_u32 s60, s60, 2048
    s_mov_b32 m0, s60
    s_add_u32 s61, s64, 20480
    buffer_load_dwordx4 v16, s[28:31], s61 offen lds
    s_add_u32 s60, s60, 2048
    s_mov_b32 m0, s60
    s_add_u32 s61, s64, 40960
    buffer_load_dwordx4 v16, s[28:31], s61 offen lds
    s_add_u32 s60, s60, 2048
    s_mov_b32 m0, s60
    s_add_u32 s61, s64, 61440
    buffer_load_dwordx4 v16, s[28:31], s61 offen lds
    s_add_u32 s60, s60, 2048
    s_mov_b32 m0, s60
    s_add_u32 s61, s64, 81920
    buffer_load_dwordx4 v16, s[28:31], s61 offen lds
    s_add_u32 s60, s60, 2048
    s_mov_b32 m0, s60
    s_add_u32 s61, s64, 102400
    buffer_load_dwordx4 v16, s[28:31], s61 offen lds
    s_add_u32 s60, s60, 2048
    s_mov_b32 m0, s60
    s_add_u32 s61, s64, 122880
    buffer_load_dwordx4 v16, s[28:31], s61 offen lds
    s_add_u32 s60, s60, 2048
    s_mov_b32 m0, s60
    s_add_u32 s61, s64, 143360
    buffer_load_dwordx4 v16, s[28:31], s61 offen lds
    s_add_u32 s64, s64, 128
    s_add_u32 s70, s70, 16384
    s_cmp_eq_u32 s70, 65536
    s_cselect_b32 s70, 0, s70
    s_add_u32 s60, s68, s67
    s_mov_b32 m0, s60
    s_add_u32 s61, s65, 0
    buffer_load_dwordx4 v17, s[32:35], s61 offen lds
    s_add_u32 s60, s68, s67
    s_add_u32 s60, s60, 1024
    s_mov_b32 m0, s60
    s_add_u32 s61, s65, 15360
    buffer_load_dwordx4 v17, s[32:35], s61 offen lds
    s_add_u32 s60, s68, s67
    s_add_u32 s60, s60, 4096
    s_mov_b32 m0, s60
    s_add_u32 s61, s65, 61440
    buffer_load_dwordx4 v17, s[32:35], s61 offen lds
    s_add_u32 s60, s68, s67
    s_add_u32 s60, s60, 5120
    s_mov_b32 m0, s60
    s_add_u32 s61, s65, 76800
    buffer_load_dwordx4 v17, s[32:35], s61 offen lds
    s_add_u32 s60, s68, s67
    s_add_u32 s60, s60, 8192
    s_mov_b32 m0, s60
    s_add_u32 s61, s65, 122880
    buffer_load_dwordx4 v17, s[32:35], s61 offen lds
    s_add_u32 s60, s68, s67
    s_add_u32 s60, s60, 9216
    s_mov_b32 m0, s60
    s_add_u32 s61, s65, 138240
    buffer_load_dwordx4 v17, s[32:35], s61 offen lds
    s_add_u32 s60, s68, s67
    s_add_u32 s60, s60, 12288
    s_mov_b32 m0, s60
    s_add_u32 s61, s65, 184320
    buffer_load_dwordx4 v17, s[32:35], s61 offen lds
    s_add_u32 s60, s68, s67
    s_add_u32 s60, s60, 13312
    s_mov_b32 m0, s60
    s_add_u32 s61, s65, 199680
    buffer_load_dwordx4 v17, s[32:35], s61 offen lds
    s_add_u32 s65, s65, 245760
    s_add_u32 s68, s68, 16384
    s_cmp_eq_u32 s68, 81920
    s_cselect_b32 s68, 0, s68
    s_add_u32 s60, s70, s66
    s_mov_b32 m0, s60
    s_add_u32 s61, s64, 0
    buffer_load_dwordx4 v16, s[28:31], s61 offen lds
    s_add_u32 s60, s60, 2048
    s_mov_b32 m0, s60
    s_add_u32 s61, s64, 20480
    buffer_load_dwordx4 v16, s[28:31], s61 offen lds
    s_add_u32 s60, s60, 2048
    s_mov_b32 m0, s60
    s_add_u32 s61, s64, 40960
    buffer_load_dwordx4 v16, s[28:31], s61 offen lds
    s_add_u32 s60, s60, 2048
    s_mov_b32 m0, s60
    s_add_u32 s61, s64, 61440
    buffer_load_dwordx4 v16, s[28:31], s61 offen lds
    s_add_u32 s60, s60, 2048
    s_mov_b32 m0, s60
    s_add_u32 s61, s64, 81920
    buffer_load_dwordx4 v16, s[28:31], s61 offen lds
    s_add_u32 s60, s60, 2048
    s_mov_b32 m0, s60
    s_add_u32 s61, s64, 102400
    buffer_load_dwordx4 v16, s[28:31], s61 offen lds
    s_add_u32 s60, s60, 2048
    s_mov_b32 m0, s60
    s_add_u32 s61, s64, 122880
    buffer_load_dwordx4 v16, s[28:31], s61 offen lds
    s_add_u32 s60, s60, 2048
    s_mov_b32 m0, s60
    s_add_u32 s61, s64, 143360
    buffer_load_dwordx4 v16, s[28:31], s61 offen lds
    s_add_u32 s64, s64, 128
    s_add_u32 s70, s70, 16384
    s_cmp_eq_u32 s70, 65536
    s_cselect_b32 s70, 0, s70
    s_add_u32 s60, s68, s67
    s_mov_b32 m0, s60
    s_add_u32 s61, s65, 0
    buffer_load_dwordx4 v17, s[32:35], s61 offen lds
    s_add_u32 s60, s68, s67
    s_add_u32 s60, s60, 1024
    s_mov_b32 m0, s60
    s_add_u32 s61, s65, 15360
    buffer_load_dwordx4 v17, s[32:35], s61 offen lds
    s_add_u32 s60, s68, s67
    s_add_u32 s60, s60, 4096
    s_mov_b32 m0, s60
    s_add_u32 s61, s65, 61440
    buffer_load_dwordx4 v17, s[32:35], s61 offen lds
    s_add_u32 s60, s68, s67
    s_add_u32 s60, s60, 5120
    s_mov_b32 m0, s60
    s_add_u32 s61, s65, 76800
    buffer_load_dwordx4 v17, s[32:35], s61 offen lds
    s_add_u32 s60, s68, s67
    s_add_u32 s60, s60, 8192
    s_mov_b32 m0, s60
    s_add_u32 s61, s65, 122880
    buffer_load_dwordx4 v17, s[32:35], s61 offen lds
    s_add_u32 s60, s68, s67
    s_add_u32 s60, s60, 9216
    s_mov_b32 m0, s60
    s_add_u32 s61, s65, 138240
    buffer_load_dwordx4 v17, s[32:35], s61 offen lds
    s_add_u32 s60, s68, s67
    s_add_u32 s60, s60, 12288
    s_mov_b32 m0, s60
    s_add_u32 s61, s65, 184320
    buffer_load_dwordx4 v17, s[32:35], s61 offen lds
    s_add_u32 s60, s68, s67
    s_add_u32 s60, s60, 13312
    s_mov_b32 m0, s60
    s_add_u32 s61, s65, 199680
    buffer_load_dwordx4 v17, s[32:35], s61 offen lds
    s_add_u32 s65, s65, 245760
    s_add_u32 s68, s68, 16384
    s_cmp_eq_u32 s68, 81920
    s_cselect_b32 s68, 0, s68
    s_add_u32 s60, s68, s67
    s_mov_b32 m0, s60
    s_add_u32 s61, s65, 0
    buffer_load_dwordx4 v17, s[32:35], s61 offen lds
    s_add_u32 s60, s68, s67
    s_add_u32 s60, s60, 1024
    s_mov_b32 m0, s60
    s_add_u32 s61, s65, 15360
    buffer_load_dwordx4 v17, s[32:35], s61 offen lds
    s_add_u32 s60, s68, s67
    s_add_u32 s60, s60, 4096
    s_mov_b32 m0, s60
    s_add_u32 s61, s65, 61440
    buffer_load_dwordx4 v17, s[32:35], s61 offen lds
    s_add_u32 s60, s68, s67
    s_add_u32 s60, s60, 5120
    s_mov_b32 m0, s60
    s_add_u32 s61, s65, 76800
    buffer_load_dwordx4 v17, s[32:35], s61 offen lds
    s_add_u32 s60, s68, s67
    s_add_u32 s60, s60, 8192
    s_mov_b32 m0, s60
    s_add_u32 s61, s65, 122880
    buffer_load_dwordx4 v17, s[32:35], s61 offen lds
    s_add_u32 s60, s68, s67
    s_add_u32 s60, s60, 9216
    s_mov_b32 m0, s60
    s_add_u32 s61, s65, 138240
    buffer_load_dwordx4 v17, s[32:35], s61 offen lds
    s_add_u32 s60, s68, s67
    s_add_u32 s60, s60, 12288
    s_mov_b32 m0, s60
    s_add_u32 s61, s65, 184320
    buffer_load_dwordx4 v17, s[32:35], s61 offen lds
    s_add_u32 s60, s68, s67
    s_add_u32 s60, s60, 13312
    s_mov_b32 m0, s60
    s_add_u32 s61, s65, 199680
    buffer_load_dwordx4 v17, s[32:35], s61 offen lds
    s_add_u32 s65, s65, 245760
    s_add_u32 s68, s68, 16384
    s_cmp_eq_u32 s68, 81920
    s_cselect_b32 s68, 0, s68
    s_waitcnt vmcnt(24)
    s_barrier
    s_mov_b32 s69, 0
p1p_25:
    s_add_u32 s60, s70, s66
    s_mov_b32 m0, s60
    s_add_u32 s61, s64, 0
    buffer_load_dwordx4 v16, s[28:31], s61 offen lds
    s_add_u32 s60, s60, 2048
    s_mov_b32 m0, s60
    s_add_u32 s61, s64, 20480
    buffer_load_dwordx4 v16, s[28:31], s61 offen lds
    s_add_u32 s60, s60, 2048
    s_mov_b32 m0, s60
    s_add_u32 s61, s64, 40960
    buffer_load_dwordx4 v16, s[28:31], s61 offen lds
    s_add_u32 s60, s60, 2048
    s_mov_b32 m0, s60
    s_add_u32 s61, s64, 61440
    buffer_load_dwordx4 v16, s[28:31], s61 offen lds
    s_add_u32 s60, s60, 2048
    s_mov_b32 m0, s60
    s_add_u32 s61, s64, 81920
    buffer_load_dwordx4 v16, s[28:31], s61 offen lds
    s_add_u32 s60, s60, 2048
    s_mov_b32 m0, s60
    s_add_u32 s61, s64, 102400
    buffer_load_dwordx4 v16, s[28:31], s61 offen lds
    s_add_u32 s60, s60, 2048
    s_mov_b32 m0, s60
    s_add_u32 s61, s64, 122880
    buffer_load_dwordx4 v16, s[28:31], s61 offen lds
    s_add_u32 s60, s60, 2048
    s_mov_b32 m0, s60
    s_add_u32 s61, s64, 143360
    buffer_load_dwordx4 v16, s[28:31], s61 offen lds
    s_add_u32 s64, s64, 128
    s_add_u32 s70, s70, 16384
    s_cmp_eq_u32 s70, 65536
    s_cselect_b32 s70, 0, s70
    s_add_u32 s60, s68, s67
    s_mov_b32 m0, s60
    s_add_u32 s61, s65, 0
    buffer_load_dwordx4 v17, s[32:35], s61 offen lds
    s_add_u32 s60, s68, s67
    s_add_u32 s60, s60, 1024
    s_mov_b32 m0, s60
    s_add_u32 s61, s65, 15360
    buffer_load_dwordx4 v17, s[32:35], s61 offen lds
    s_add_u32 s60, s68, s67
    s_add_u32 s60, s60, 4096
    s_mov_b32 m0, s60
    s_add_u32 s61, s65, 61440
    buffer_load_dwordx4 v17, s[32:35], s61 offen lds
    s_add_u32 s60, s68, s67
    s_add_u32 s60, s60, 5120
    s_mov_b32 m0, s60
    s_add_u32 s61, s65, 76800
    buffer_load_dwordx4 v17, s[32:35], s61 offen lds
    s_add_u32 s60, s68, s67
    s_add_u32 s60, s60, 8192
    s_mov_b32 m0, s60
    s_add_u32 s61, s65, 122880
    buffer_load_dwordx4 v17, s[32:35], s61 offen lds
    s_add_u32 s60, s68, s67
    s_add_u32 s60, s60, 9216
    s_mov_b32 m0, s60
    s_add_u32 s61, s65, 138240
    buffer_load_dwordx4 v17, s[32:35], s61 offen lds
    s_add_u32 s60, s68, s67
    s_add_u32 s60, s60, 12288
    s_mov_b32 m0, s60
    s_add_u32 s61, s65, 184320
    buffer_load_dwordx4 v17, s[32:35], s61 offen lds
    s_add_u32 s60, s68, s67
    s_add_u32 s60, s60, 13312
    s_mov_b32 m0, s60
    s_add_u32 s61, s65, 199680
    buffer_load_dwordx4 v17, s[32:35], s61 offen lds
    s_add_u32 s65, s65, 245760
    s_add_u32 s68, s68, 16384
    s_cmp_eq_u32 s68, 81920
    s_cselect_b32 s68, 0, s68
    s_waitcnt vmcnt(24)
    s_barrier
    s_add_u32 s69, s69, 1
    s_cmp_lt_u32 s69, 6
    s_cbranch_scc1 p1p_25
    s_add_u32 s60, s70, s66
    s_mov_b32 m0, s60
    s_add_u32 s61, s64, 0
    buffer_load_dwordx4 v16, s[28:31], s61 offen lds
    s_add_u32 s60, s60, 2048
    s_mov_b32 m0, s60
    s_add_u32 s61, s64, 20480
    buffer_load_dwordx4 v16, s[28:31], s61 offen lds
    s_add_u32 s60, s60, 2048
    s_mov_b32 m0, s60
    s_add_u32 s61, s64, 40960
    buffer_load_dwordx4 v16, s[28:31], s61 offen lds
    s_add_u32 s60, s60, 2048
    s_mov_b32 m0, s60
    s_add_u32 s61, s64, 61440
    buffer_load_dwordx4 v16, s[28:31], s61 offen lds
    s_add_u32 s60, s60, 2048
    s_mov_b32 m0, s60
    s_add_u32 s61, s64, 81920
    buffer_load_dwordx4 v16, s[28:31], s61 offen lds
    s_add_u32 s60, s60, 2048
    s_mov_b32 m0, s60
    s_add_u32 s61, s64, 102400
    buffer_load_dwordx4 v16, s[28:31], s61 offen lds
    s_add_u32 s60, s60, 2048
    s_mov_b32 m0, s60
    s_add_u32 s61, s64, 122880
    buffer_load_dwordx4 v16, s[28:31], s61 offen lds
    s_add_u32 s60, s60, 2048
    s_mov_b32 m0, s60
    s_add_u32 s61, s64, 143360
    buffer_load_dwordx4 v16, s[28:31], s61 offen lds
    s_add_u32 s64, s64, 128
    s_add_u32 s70, s70, 16384
    s_cmp_eq_u32 s70, 65536
    s_cselect_b32 s70, 0, s70
    s_waitcnt vmcnt(16)
    s_barrier
    s_waitcnt vmcnt(0)
    s_barrier
    s_barrier
    s_barrier
    s_barrier
    s_barrier
    s_branch L_p2
L_p1_sv:
    v_mov_b32 v3, 0
    v_mov_b32 v4, 0
    s_mov_b64 s[62:63], exec
    s_lshl_b32 s60, s52, 8
    s_lshl_b32 s61, s53, 2
    s_add_u32 s60, s60, s61
    s_mov_b64 exec, 1
    buffer_store_dword v3, v4, s[36:39], s60 offen sc0 sc1
    s_cmp_lt_u32 s53, 10
    s_cbranch_scc1 nox_26
    s_cmp_ge_u32 s53, 30
    s_cbranch_scc1 nox_26
    s_lshl_b32 s60, s52, 9
    s_sub_u32 s61, s53, 10
    s_lshl_b32 s61, s61, 4
    s_add_u32 s60, s60, s61
    s_add_u32 s60, s60, 0x1000
    s_mov_b64 exec, 15
    v_lshlrev_b32 v5, 2, v2
    buffer_store_dword v3, v5, s[36:39], s60 offen sc0 sc1
nox_26:
    s_cmp_eq_u32 s52, 0
    s_cbranch_scc1 noh_27
    s_sub_u32 s60, s52, 1
    s_lshl_b32 s60, s60, 8
    s_lshl_b32 s61, s53, 2
    s_add_u32 s60, s60, s61
    s_add_u32 s60, s60, 0x3000
    s_mov_b64 exec, 1
    buffer_store_dword v3, v4, s[36:39], s60 offen sc0 sc1
noh_27:
    s_lshl_b32 s60, s2, 2
    s_add_u32 s60, s60, 0x2000
    s_mov_b64 exec, 1
    buffer_store_dword v3, v4, s[36:39], s60 offen sc0 sc1
    s_mov_b64 exec, s[62:63]
    s_barrier
    s_barrier
    s_barrier
    s_barrier
    s_waitcnt vmcnt(0)
    s_getreg_b32 s60, hwreg(HW_REG_XCC_ID)
    s_and_b32 s60, s60, 15
    s_or_b32 s60, s60, 0x80
    v_mov_b32 v3, s60
    v_mov_b32 v4, 0
    s_lshl_b32 s60, s52, 5
    s_add_u32 s60, s60, s53
    s_mov_b64 s[62:63], exec
    s_mov_b64 exec, 1
    buffer_store_byte v3, v4, s[44:47], s60 offen sc0 sc1
    s_mov_b64 exec, s[62:63]
    s_barrier
    s_barrier
    s_barrier
    v_lshlrev_b32 v3, 2, v2
    buffer_load_dword v20, v3, s[44:47], 0 offen sc1
    s_barrier
    s_barrier
    s_waitcnt vmcnt(0)
    v_and_b32 v5, 0x80808080, v20
    v_cmp_ne_u32 vcc, 0x80808080, v5
    s_mov_b32 s91, 0
    s_cbranch_vccnz arn_28
    s_getreg_b32 s60, hwreg(HW_REG_XCC_ID)
    s_and_b32 s60, s60, 15
    s_or_b32 s60, s60, 0x80
    s_mul_i32 s60, s60, 0x01010101
    v_cmp_ne_u32 vcc, s60, v20
    s_mov_b64 s[60:61], 0xff
    s_lshl_b32 s62, s52, 3
    s_lshl_b64 s[60:61], s[60:61], s62
    s_and_b64 s[60:61], s[60:61], vcc
    s_cmp_lg_u64 s[60:61], 0
    s_cselect_b32 s55, 1, 0
    s_mov_b32 s91, 1
arn_28:
    s_barrier
    s_barrier
    s_barrier
    s_barrier
    s_cmp_eq_u32 s91, 1
    s_cbranch_scc1 arok_29
    v_lshlrev_b32 v3, 2, v2
    s_mov_b32 s92, 0
arr_30:
    buffer_load_dword v20, v3, s[44:47], 0 offen sc1
    s_waitcnt vmcnt(0)
    v_and_b32 v5, 0x80808080, v20
    v_cmp_ne_u32 vcc, 0x80808080, v5
    s_cbranch_vccz arrd_31
    s_sleep 48
    s_add_u32 s92, s92, 1
    s_cmp_lt_u32 s92, 0x20000
    s_cbranch_scc1 arr_30
arrd_31:
    s_getreg_b32 s60, hwreg(HW_REG_XCC_ID)
    s_and_b32 s60, s60, 15
    s_or_b32 s60, s60, 0x80
    s_mul_i32 s60, s60, 0x01010101
    v_cmp_ne_u32 vcc, s60, v20
    s_mov_b64 s[60:61], 0xff
    s_lshl_b32 s62, s52, 3
    s_lshl_b64 s[60:61], s[60:61], s62
    s_and_b64 s[60:61], s[60:61], vcc
    s_cmp_lg_u64 s[60:61], 0
    s_cselect_b32 s55, 1, 0
arok_29:
    v_mov_b32 v242, 2
    s_mov_b64 exec, 1
    s_cmp_lg_u32 s55, 0
    s_cbranch_scc1 fmix_32
    buffer_store_dword v242, v241, s[36:39], s27 offen
fdone_33:
    s_mov_b64 exec, -1
    s_branch L_p2
L_p1_sp:
    v_lshlrev_b32 v21, 7, v2
    v_lshlrev_b32 v22, 21, v2
    s_mov_b64 exec, 0x3ffff
    s_mov_b32 s60, 0x0
    buffer_load_dword v20, v22, s[36:39], s60 offen offset:3968
    s_mov_b64 exec, 3
    buffer_load_dword v20, v22, s[40:43], 0 offen
    s_mov_b64 exec, -1
    s_cmp_ge_u32 s53, 6
    s_cbranch_scc1 cpf_34
    s_mov_b32 s80, s100
    s_mov_b32 s81, s101
    s_mov_b32 s82, L_codeend-sequential_preLN__sliding_block__dense_activation_gelu__prompt_kernel-4
    s_mov_b32 s83, 0x00020000
    s_lshl_b32 s60, s53, 13
    buffer_load_dword v20, v21, s[80:83], s60 offen
cpf_34:
    s_lshl_b32 s60, s52, 8
    s_lshl_b32 s61, s53, 3
    s_add_u32 s60, s60, s61
    s_mul_i32 s60, s60, 1280
    buffer_load_dword v20, v21, s[28:31], s60 offen
    s_add_u32 s60, s60, 8192
    s_mov_b64 exec, 0xffff
    buffer_load_dword v20, v21, s[28:31], s60 offen
    s_mov_b64 exec, -1
    s_mul_i32 s60, s2, 4800
    s_and_b32 s60, s60, 0xffffff80
    s_mov_b32 exec_hi, 0x7f
    buffer_load_dword v20, v21, s[32:35], s60 offen
    s_mov_b64 exec, -1
    s_mul_i32 s60, s2, 4800
    s_and_b32 s60, s60, 0xffffff80
    s_add_u32 s60, s60, 1228800
    s_mov_b32 exec_hi, 0x7f
    buffer_load_dword v20, v21, s[32:35], s60 offen
    s_mov_b64 exec, -1
    s_cmp_ge_u32 s53, 30
    s_cbranch_scc1 rlidle_35
    s_barrier
    s_barrier
    s_barrier
    s_barrier
    v_lshrrev_b32 v3, 3, v2
    v_and_b32 v4, 7, v2
    v_lshlrev_b32 v4, 4, v4
    v_lshrrev_b32 v9, 2, v3
    v_and_b32 v10, 3, v3
    s_mov_b32 s80, s8
    s_mov_b32 s81, s9
    s_mov_b32 s82, 0xc8000
    s_mov_b32 s83, 0x00020000
    s_add_u32 s66, s2, 0
    s_mul_hi_u32 s67, s66, 0x1999999a
    s_mul_i32 s60, s67, 10
    s_sub_u32 s70, s66, s60
    s_mul_i32 s84, s67, 5120
    s_add_u32 s84, s84, 0x2000000
    s_cmp_ge_u32 s66, 200
    s_cselect_b32 s84, 0x20000000, s84
    s_cmp_ge_u32 s67, 16
    s_cbranch_scc1 rlt_36
    s_lshl_b32 s60, s67, 1
    s_add_u32 s60, s60, 0
    s_mul_i32 s60, s60, 20
    s_add_u32 s60, s60, 0
    v_lshlrev_b32 v11, 2, v9
    v_add_u32 v11, v11, v10
    v_add_u32 v12, s60, v11
    s_lshl_b32 s60, s67, 1
    s_add_u32 s60, s60, 1
    s_mul_i32 s60, s60, 20
    s_add_u32 s60, s60, 0
    v_lshlrev_b32 v11, 2, v9
    v_add_u32 v11, v11, v10
    v_add_u32 v13, s60, v11
    s_lshl_b32 s60, s67, 1
    s_add_u32 s60, s60, 0
    s_mul_i32 s60, s60, 20
    s_add_u32 s60, s60, 8
    v_lshlrev_b32 v11, 2, v9
    v_add_u32 v11, v11, v10
    v_add_u32 v14, s60, v11
    s_lshl_b32 s60, s67, 1
    s_add_u32 s60, s60, 1
    s_mul_i32 s60, s60, 20
    s_add_u32 s60, s60, 8
    v_lshlrev_b32 v11, 2, v9
    v_add_u32 v11, v11, v10
    v_add_u32 v15, s60, v11
    s_branch rlj_37
rlt_36:
    s_sub_u32 s60, s67, 16
    s_lshl_b32 s60, s60, 2
    s_add_u32 s60, s60, 0
    s_mul_i32 s60, s60, 40
    s_add_u32 s60, s60, 16
    v_mul_u32_u24 v11, 40, v9
    v_add_u32 v11, v11, v10
    v_add_u32 v12, s60, v11
    s_sub_u32 s60, s67, 16
    s_lshl_b32 s60, s60, 2
    s_add_u32 s60, s60, 2
    s_mul_i32 s60, s60, 40
    s_add_u32 s60, s60, 16
    v_mul_u32_u24 v11, 40, v9
    v_add_u32 v11, v11, v10
    v_add_u32 v13, s60, v11
    s_sub_u32 s60, s67, 16
    s_lshl_b32 s60, s60, 2
    s_add_u32 s60, s60, 0
    s_mul_i32 s60, s60, 40
    s_add_u32 s60, s60, 36
    v_mul_u32_u24 v11, 40, v9
    v_add_u32 v11, v11, v10
    v_add_u32 v14, s60, v11
    s_sub_u32 s60, s67, 16
    s_lshl_b32 s60, s60, 2
    s_add_u32 s60, s60, 2
    s_mul_i32 s60, s60, 40
    s_add_u32 s60, s60, 36
    v_mul_u32_u24 v11, 40, v9
    v_add_u32 v11, v11, v10
    v_add_u32 v15, s60, v11
rlj_37:
    s_lshl_b32 s60, s70, 7
    v_add_u32 v11, s60, v4
    v_mul_u32_u24 v12, 1280, v12
    v_add_u32 v12, v12, v11
    v_mul_u32_u24 v13, 1280, v13
    v_add_u32 v13, v13, v11
    v_mul_u32_u24 v14, 1280, v14
    v_add_u32 v14, v14, v11
    v_mul_u32_u24 v15, 1280, v15
    v_add_u32 v15, v15, v11
    s_mov_b32 m0, 147968
    s_nop 0
    buffer_load_dwordx4 v12, s[80:83], 0 offen lds
    s_mov_b32 m0, 148992
    s_nop 0
    buffer_load_dwordx4 v13, s[80:83], 0 offen lds
    s_mov_b32 m0, 150016
    s_nop 0
    buffer_load_dwordx4 v14, s[80:83], 0 offen lds
    s_mov_b32 m0, 151040
    s_nop 0
    buffer_load_dwordx4 v15, s[80:83], 0 offen lds
    s_barrier
    s_barrier
    s_barrier
    s_barrier
    s_waitcnt vmcnt(0)
    v_lshlrev_b32 v8, 4, v2
    v_lshrrev_b32 v5, 4, v2
    v_and_b32 v7, 15, v2
    v_lshrrev_b32 v11, 2, v7
    v_and_b32 v7, 3, v7
    v_lshlrev_b32 v5, 2, v5
    v_add_u32 v5, v5, v11
    v_lshlrev_b32 v5, 7, v5
    v_lshlrev_b32 v7, 3, v7
    v_add_u32 v5, v5, v7
    v_add_u32 v5, 147968, v5
    ds_read_b64_tr_b16 v[160:161], v5 offset:0
    ds_read_b64_tr_b16 v[162:163], v5 offset:2048
    ds_read_b64_tr_b16 v[164:165], v5 offset:32
    ds_read_b64_tr_b16 v[166:167], v5 offset:2080
    ds_read_b64_tr_b16 v[168:169], v5 offset:64
    ds_read_b64_tr_b16 v[170:171], v5 offset:2112
    ds_read_b64_tr_b16 v[172:173], v5 offset:96
    ds_read_b64_tr_b16 v[174:175], v5 offset:2144
    s_waitcnt lgkmcnt(0)
    s_lshl_b32 s60, s70, 2
    s_add_u32 s60, s60, 0
    s_mul_i32 s61, s60, 52429
    s_lshr_b32 s61, s61, 18
    s_mul_i32 s62, s61, 5
    s_sub_u32 s62, s60, s62
    s_and_b32 s63, s61, 1
    s_add_u32 s62, s62, 5
    s_sub_u32 s62, s62, s63
    s_cmp_ge_u32 s62, 5
    s_cselect_b32 s63, 5, 0
    s_sub_u32 s62, s62, s63
    s_mul_i32 s61, s61, 102400
    s_lshl_b32 s62, s62, 10
    s_add_u32 s61, s61, s62
    s_add_u32 s61, s61, s84
    buffer_store_dwordx4 v[160:163], v8, s[36:39], s61 offen sc0 sc1
    s_lshl_b32 s60, s70, 2
    s_add_u32 s60, s60, 1
    s_mul_i32 s61, s60, 52429
    s_lshr_b32 s61, s61, 18
    s_mul_i32 s62, s61, 5
    s_sub_u32 s62, s60, s62
    s_and_b32 s63, s61, 1
    s_add_u32 s62, s62, 5
    s_sub_u32 s62, s62, s63
    s_cmp_ge_u32 s62, 5
    s_cselect_b32 s63, 5, 0
    s_sub_u32 s62, s62, s63
    s_mul_i32 s61, s61, 102400
    s_lshl_b32 s62, s62, 10
    s_add_u32 s61, s61, s62
    s_add_u32 s61, s61, s84
    buffer_store_dwordx4 v[164:167], v8, s[36:39], s61 offen sc0 sc1
    s_lshl_b32 s60, s70, 2
    s_add_u32 s60, s60, 2
    s_mul_i32 s61, s60, 52429
    s_lshr_b32 s61, s61, 18
    s_mul_i32 s62, s61, 5
    s_sub_u32 s62, s60, s62
    s_and_b32 s63, s61, 1
    s_add_u32 s62, s62, 5
    s_sub_u32 s62, s62, s63
    s_cmp_ge_u32 s62, 5
    s_cselect_b32 s63, 5, 0
    s_sub_u32 s62, s62, s63
    s_mul_i32 s61, s61, 102400
    s_lshl_b32 s62, s62, 10
    s_add_u32 s61, s61, s62
    s_add_u32 s61, s61, s84
    buffer_store_dwordx4 v[168:171], v8, s[36:39], s61 offen sc0 sc1
    s_lshl_b32 s60, s70, 2
    s_add_u32 s60, s60, 3
    s_mul_i32 s61, s60, 52429
    s_lshr_b32 s61, s61, 18
    s_mul_i32 s62, s61, 5
    s_sub_u32 s62, s60, s62
    s_and_b32 s63, s61, 1
    s_add_u32 s62, s62, 5
    s_sub_u32 s62, s62, s63
    s_cmp_ge_u32 s62, 5
    s_cselect_b32 s63, 5, 0
    s_sub_u32 s62, s62, s63
    s_mul_i32 s61, s61, 102400
    s_lshl_b32 s62, s62, 10
    s_add_u32 s61, s61, s62
    s_add_u32 s61, s61, s84
    buffer_store_dwordx4 v[172:175], v8, s[36:39], s61 offen sc0 sc1
    v_lshlrev_b32 v26, 7, v2
    s_mul_i32 s64, s52, 0x50000
    s_add_u32 s64, s64, 0x1400000
    s_and_b32 s60, s53, 3
    s_mul_i32 s60, s60, 81920
    s_add_u32 s64, s64, s60
    s_lshr_b32 s60, s53, 2
    s_mul_i32 s60, s60, 2560
    s_add_u32 s64, s64, s60
    v_lshrrev_b32 v27, 4, v2
    v_mul_u32_u24 v27, 20480, v27
    v_and_b32 v28, 15, v2
    v_lshlrev_b32 v28, 7, v28
    v_add_u32 v27, v27, v28
    buffer_load_dword v20, v27, s[36:39], s64 offen sc1
    s_mov_b32 exec_lo, 0x000f000f
    s_mov_b32 exec_hi, 0x000f000f
    buffer_load_dword v20, v27, s[36:39], s64 offen offset:2048 sc1
    s_lshl_b32 s60, s52, 14
    s_lshr_b32 s61, s53, 2
    s_lshl_b32 s61, s61, 11
    s_add_u32 s60, s60, s61
    s_and_b32 s61, s53, 3
    s_lshl_b32 s61, s61, 9
    s_add_u32 s60, s60, s61
    s_add_u32 s60, s60, 0x20000
    s_mov_b64 exec, 0xf
    buffer_load_dword v20, v26, s[36:39], s60 offen sc1
    s_mov_b64 exec, -1
    s_barrier
    s_barrier
    s_barrier
    s_barrier
    s_barrier
    s_waitcnt vmcnt(3)
    s_lshl_b32 s60, s2, 2
    s_add_u32 s60, s60, 0x2000
    v_mov_b32 v3, 1
    v_mov_b32 v4, 0
    s_mov_b64 s[62:63], exec
    s_mov_b64 exec, 1
    buffer_store_dword v3, v4, s[36:39], s60 offen sc0 sc1
    s_mov_b64 exec, s[62:63]
    s_branch L_p2
rlidle_35:
    s_barrier
    v_lshrrev_b32 v3, 3, v2
    v_and_b32 v4, 7, v2
    v_lshlrev_b32 v4, 4, v4
    v_lshrrev_b32 v9, 2, v3
    v_and_b32 v10, 3, v3
    s_mov_b32 s80, s8
    s_mov_b32 s81, s9
    s_mov_b32 s82, 0xc8000
    s_mov_b32 s83, 0x00020000
    s_add_u32 s66, s2, 0
    s_mul_hi_u32 s67, s66, 0x1999999a
    s_mul_i32 s60, s67, 10
    s_sub_u32 s70, s66, s60
    s_mul_i32 s84, s67, 5120
    s_add_u32 s84, s84, 0x2000000
    s_cmp_ge_u32 s66, 200
    s_cselect_b32 s84, 0x20000000, s84
    s_cmp_ge_u32 s67, 16
    s_cbranch_scc1 rlt_38
    s_lshl_b32 s60, s67, 1
    s_add_u32 s60, s60, 0
    s_mul_i32 s60, s60, 20
    s_add_u32 s60, s60, 0
    v_lshlrev_b32 v11, 2, v9
    v_add_u32 v11, v11, v10
    v_add_u32 v12, s60, v11
    s_lshl_b32 s60, s67, 1
    s_add_u32 s60, s60, 1
    s_mul_i32 s60, s60, 20
    s_add_u32 s60, s60, 0
    v_lshlrev_b32 v11, 2, v9
    v_add_u32 v11, v11, v10
    v_add_u32 v13, s60, v11
    s_lshl_b32 s60, s67, 1
    s_add_u32 s60, s60, 0
    s_mul_i32 s60, s60, 20
    s_add_u32 s60, s60, 8
    v_lshlrev_b32 v11, 2, v9
    v_add_u32 v11, v11, v10
    v_add_u32 v14, s60, v11
    s_lshl_b32 s60, s67, 1
    s_add_u32 s60, s60, 1
    s_mul_i32 s60, s60, 20
    s_add_u32 s60, s60, 8
    v_lshlrev_b32 v11, 2, v9
    v_add_u32 v11, v11, v10
    v_add_u32 v15, s60, v11
    s_branch rlj_39
rlt_38:
    s_sub_u32 s60, s67, 16
    s_lshl_b32 s60, s60, 2
    s_add_u32 s60, s60, 0
    s_mul_i32 s60, s60, 40
    s_add_u32 s60, s60, 16
    v_mul_u32_u24 v11, 40, v9
    v_add_u32 v11, v11, v10
    v_add_u32 v12, s60, v11
    s_sub_u32 s60, s67, 16
    s_lshl_b32 s60, s60, 2
    s_add_u32 s60, s60, 2
    s_mul_i32 s60, s60, 40
    s_add_u32 s60, s60, 16
    v_mul_u32_u24 v11, 40, v9
    v_add_u32 v11, v11, v10
    v_add_u32 v13, s60, v11
    s_sub_u32 s60, s67, 16
    s_lshl_b32 s60, s60, 2
    s_add_u32 s60, s60, 0
    s_mul_i32 s60, s60, 40
    s_add_u32 s60, s60, 36
    v_mul_u32_u24 v11, 40, v9
    v_add_u32 v11, v11, v10
    v_add_u32 v14, s60, v11
    s_sub_u32 s60, s67, 16
    s_lshl_b32 s60, s60, 2
    s_add_u32 s60, s60, 2
    s_mul_i32 s60, s60, 40
    s_add_u32 s60, s60, 36
    v_mul_u32_u24 v11, 40, v9
    v_add_u32 v11, v11, v10
    v_add_u32 v15, s60, v11
rlj_39:
    s_lshl_b32 s60, s70, 7
    v_add_u32 v11, s60, v4
    v_mul_u32_u24 v12, 1280, v12
    v_add_u32 v12, v12, v11
    v_mul_u32_u24 v13, 1280, v13
    v_add_u32 v13, v13, v11
    v_mul_u32_u24 v14, 1280, v14
    v_add_u32 v14, v14, v11
    v_mul_u32_u24 v15, 1280, v15
    v_add_u32 v15, v15, v11
    s_mov_b32 m0, 147968
    s_nop 0
    buffer_load_dwordx4 v12, s[80:83], 0 offen lds
    s_mov_b32 m0, 148992
    s_nop 0
    buffer_load_dwordx4 v13, s[80:83], 0 offen lds
    s_mov_b32 m0, 150016
    s_nop 0
    buffer_load_dwordx4 v14, s[80:83], 0 offen lds
    s_mov_b32 m0, 151040
    s_nop 0
    buffer_load_dwordx4 v15, s[80:83], 0 offen lds
    s_waitcnt vmcnt(0)
    v_lshlrev_b32 v8, 4, v2
    v_lshrrev_b32 v5, 4, v2
    v_and_b32 v7, 15, v2
    v_lshrrev_b32 v11, 2, v7
    v_and_b32 v7, 3, v7
    v_lshlrev_b32 v5, 2, v5
    v_add_u32 v5, v5, v11
    v_lshlrev_b32 v5, 7, v5
    v_lshlrev_b32 v7, 3, v7
    v_add_u32 v5, v5, v7
    v_add_u32 v5, 147968, v5
    ds_read_b64_tr_b16 v[160:161], v5 offset:0
    ds_read_b64_tr_b16 v[162:163], v5 offset:2048
    ds_read_b64_tr_b16 v[164:165], v5 offset:32
    ds_read_b64_tr_b16 v[166:167], v5 offset:2080
    ds_read_b64_tr_b16 v[168:169], v5 offset:64
    ds_read_b64_tr_b16 v[170:171], v5 offset:2112
    ds_read_b64_tr_b16 v[172:173], v5 offset:96
    ds_read_b64_tr_b16 v[174:175], v5 offset:2144
    s_waitcnt lgkmcnt(0)
    s_lshl_b32 s60, s70, 2
    s_add_u32 s60, s60, 0
    s_mul_i32 s61, s60, 52429
    s_lshr_b32 s61, s61, 18
    s_mul_i32 s62, s61, 5
    s_sub_u32 s62, s60, s62
    s_and_b32 s63, s61, 1
    s_add_u32 s62, s62, 5
    s_sub_u32 s62, s62, s63
    s_cmp_ge_u32 s62, 5
    s_cselect_b32 s63, 5, 0
    s_sub_u32 s62, s62, s63
    s_mul_i32 s61, s61, 102400
    s_lshl_b32 s62, s62, 10
    s_add_u32 s61, s61, s62
    s_add_u32 s61, s61, s84
    buffer_store_dwordx4 v[160:163], v8, s[36:39], s61 offen sc0 sc1
    s_lshl_b32 s60, s70, 2
    s_add_u32 s60, s60, 1
    s_mul_i32 s61, s60, 52429
    s_lshr_b32 s61, s61, 18
    s_mul_i32 s62, s61, 5
    s_sub_u32 s62, s60, s62
    s_and_b32 s63, s61, 1
    s_add_u32 s62, s62, 5
    s_sub_u32 s62, s62, s63
    s_cmp_ge_u32 s62, 5
    s_cselect_b32 s63, 5, 0
    s_sub_u32 s62, s62, s63
    s_mul_i32 s61, s61, 102400
    s_lshl_b32 s62, s62, 10
    s_add_u32 s61, s61, s62
    s_add_u32 s61, s61, s84
    buffer_store_dwordx4 v[164:167], v8, s[36:39], s61 offen sc0 sc1
    s_lshl_b32 s60, s70, 2
    s_add_u32 s60, s60, 2
    s_mul_i32 s61, s60, 52429
    s_lshr_b32 s61, s61, 18
    s_mul_i32 s62, s61, 5
    s_sub_u32 s62, s60, s62
    s_and_b32 s63, s61, 1
    s_add_u32 s62, s62, 5
    s_sub_u32 s62, s62, s63
    s_cmp_ge_u32 s62, 5
    s_cselect_b32 s63, 5, 0
    s_sub_u32 s62, s62, s63
    s_mul_i32 s61, s61, 102400
    s_lshl_b32 s62, s62, 10
    s_add_u32 s61, s61, s62
    s_add_u32 s61, s61, s84
    buffer_store_dwordx4 v[168:171], v8, s[36:39], s61 offen sc0 sc1
    s_lshl_b32 s60, s70, 2
    s_add_u32 s60, s60, 3
    s_mul_i32 s61, s60, 52429
    s_lshr_b32 s61, s61, 18
    s_mul_i32 s62, s61, 5
    s_sub_u32 s62, s60, s62
    s_and_b32 s63, s61, 1
    s_add_u32 s62, s62, 5
    s_sub_u32 s62, s62, s63
    s_cmp_ge_u32 s62, 5
    s_cselect_b32 s63, 5, 0
    s_sub_u32 s62, s62, s63
    s_mul_i32 s61, s61, 102400
    s_lshl_b32 s62, s62, 10
    s_add_u32 s61, s61, s62
    s_add_u32 s61, s61, s84
    buffer_store_dwordx4 v[172:175], v8, s[36:39], s61 offen sc0 sc1
    s_waitcnt vmcnt(0)
    s_lshl_b32 s60, s2, 2
    s_add_u32 s60, s60, 0x2000
    v_mov_b32 v3, 1
    v_mov_b32 v4, 0
    s_mov_b64 s[62:63], exec
    s_mov_b64 exec, 1
    buffer_store_dword v3, v4, s[36:39], s60 offen sc0 sc1
    s_mov_b64 exec, s[62:63]
    v_lshlrev_b32 v26, 7, v2
    s_mul_i32 s64, s52, 0x50000
    s_add_u32 s64, s64, 0x1400000
    s_and_b32 s60, s53, 3
    s_mul_i32 s60, s60, 81920
    s_add_u32 s64, s64, s60
    s_lshr_b32 s60, s53, 2
    s_mul_i32 s60, s60, 2560
    s_add_u32 s64, s64, s60
    v_lshrrev_b32 v27, 4, v2
    v_mul_u32_u24 v27, 20480, v27
    v_and_b32 v28, 15, v2
    v_lshlrev_b32 v28, 7, v28
    v_add_u32 v27, v27, v28
    buffer_load_dword v20, v27, s[36:39], s64 offen sc1
    s_mov_b32 exec_lo, 0x000f000f
    s_mov_b32 exec_hi, 0x000f000f
    buffer_load_dword v20, v27, s[36:39], s64 offen offset:2048 sc1
    s_lshl_b32 s60, s52, 14
    s_lshr_b32 s61, s53, 2
    s_lshl_b32 s61, s61, 11
    s_add_u32 s60, s60, s61
    s_and_b32 s61, s53, 3
    s_lshl_b32 s61, s61, 9
    s_add_u32 s60, s60, s61
    s_add_u32 s60, s60, 0x20000
    s_mov_b64 exec, 0xf
    buffer_load_dword v20, v26, s[36:39], s60 offen sc1
    s_mov_b64 exec, -1
    s_branch L_p2
L_idle:
    s_cmp_lg_u32 s54, 6
    s_cbranch_scc1 idsv_40
    v_mov_b32 v3, 0
    v_mov_b32 v4, 0
    s_mov_b64 s[62:63], exec
    s_lshl_b32 s60, s52, 8
    s_lshl_b32 s61, s53, 2
    s_add_u32 s60, s60, s61
    s_mov_b64 exec, 1
    buffer_store_dword v3, v4, s[36:39], s60 offen sc0 sc1
    s_cmp_lt_u32 s53, 10
    s_cbranch_scc1 nox_41
    s_cmp_ge_u32 s53, 30
    s_cbranch_scc1 nox_41
    s_lshl_b32 s60, s52, 9
    s_sub_u32 s61, s53, 10
    s_lshl_b32 s61, s61, 4
    s_add_u32 s60, s60, s61
    s_add_u32 s60, s60, 0x1000
    s_mov_b64 exec, 15
    v_lshlrev_b32 v5, 2, v2
    buffer_store_dword v3, v5, s[36:39], s60 offen sc0 sc1
nox_41:
    s_cmp_eq_u32 s52, 0
    s_cbranch_scc1 noh_42
    s_sub_u32 s60, s52, 1
    s_lshl_b32 s60, s60, 8
    s_lshl_b32 s61, s53, 2
    s_add_u32 s60, s60, s61
    s_add_u32 s60, s60, 0x3000
    s_mov_b64 exec, 1
    buffer_store_dword v3, v4, s[36:39], s60 offen sc0 sc1
noh_42:
    s_lshl_b32 s60, s2, 2
    s_add_u32 s60, s60, 0x2000
    s_mov_b64 exec, 1
    buffer_store_dword v3, v4, s[36:39], s60 offen sc0 sc1
    s_mov_b64 exec, s[62:63]
    s_waitcnt vmcnt(0)
    s_getreg_b32 s60, hwreg(HW_REG_XCC_ID)
    s_and_b32 s60, s60, 15
    s_or_b32 s60, s60, 0x80
    v_mov_b32 v3, s60
    v_mov_b32 v4, 0
    s_lshl_b32 s60, s52, 5
    s_add_u32 s60, s60, s53
    s_mov_b64 s[62:63], exec
    s_mov_b64 exec, 1
    buffer_store_byte v3, v4, s[44:47], s60 offen sc0 sc1
    s_mov_b64 exec, s[62:63]
    v_mov_b32 v242, 2
    s_mov_b64 exec, 1
    buffer_store_dword v242, v241, s[36:39], s27 offen sc0 sc1
    s_mov_b64 exec, -1
    s_barrier
    s_branch L_p2
idsv_40:
    s_barrier
    s_lshl_b32 s64, s52, 1
    s_add_u32 s64, s64, s53
    s_sub_u32 s64, s64, 30
    s_mul_i32 s64, s64, 6
    s_add_u32 s64, s64, s54
    v_lshlrev_b32 v21, 7, v2
    s_mov_b32 s80, s12
    s_mov_b32 s81, s13
    s_mov_b32 s82, 0x21c000
    s_mov_b32 s83, 0x00020000
    s_mov_b32 s84, s16
    s_mov_b32 s85, s17
    s_mov_b32 s86, 0x21c000
    s_mov_b32 s87, 0x00020000
    s_add_u32 s60, s64, 0
    s_cmp_ge_u32 s60, 270
    s_cbranch_scc1 mp2_43
    s_lshl_b32 s60, s60, 13
    buffer_load_dword v20, v21, s[80:83], s60 offen
    s_branch mpn_44
mp2_43:
    s_sub_u32 s60, s60, 270
    s_lshl_b32 s60, s60, 13
    buffer_load_dword v20, v21, s[84:87], s60 offen
mpn_44:
    s_add_u32 s60, s64, 96
    s_cmp_ge_u32 s60, 270
    s_cbranch_scc1 mp2_45
    s_lshl_b32 s60, s60, 13
    buffer_load_dword v20, v21, s[80:83], s60 offen
    s_branch mpn_46
mp2_45:
    s_sub_u32 s60, s60, 270
    s_lshl_b32 s60, s60, 13
    buffer_load_dword v20, v21, s[84:87], s60 offen
mpn_46:
    s_add_u32 s60, s64, 192
    s_cmp_ge_u32 s60, 270
    s_cbranch_scc1 mp2_47
    s_lshl_b32 s60, s60, 13
    buffer_load_dword v20, v21, s[80:83], s60 offen
    s_branch mpn_48
mp2_47:
    s_sub_u32 s60, s60, 270
    s_lshl_b32 s60, s60, 13
    buffer_load_dword v20, v21, s[84:87], s60 offen
mpn_48:
    s_add_u32 s60, s64, 288
    s_cmp_ge_u32 s60, 270
    s_cbranch_scc1 mp2_49
    s_lshl_b32 s60, s60, 13
    buffer_load_dword v20, v21, s[80:83], s60 offen
    s_branch mpn_50
mp2_49:
    s_sub_u32 s60, s60, 270
    s_lshl_b32 s60, s60, 13
    buffer_load_dword v20, v21, s[84:87], s60 offen
mpn_50:
    s_add_u32 s60, s64, 384
    s_cmp_ge_u32 s60, 270
    s_cbranch_scc1 mp2_51
    s_lshl_b32 s60, s60, 13
    buffer_load_dword v20, v21, s[80:83], s60 offen
    s_branch mpn_52
mp2_51:
    s_sub_u32 s60, s60, 270
    s_lshl_b32 s60, s60, 13
    buffer_load_dword v20, v21, s[84:87], s60 offen
mpn_52:
    s_add_u32 s60, s64, 480
    s_cmp_ge_u32 s60, 270
    s_cbranch_scc1 mp2_53
    s_lshl_b32 s60, s60, 13
    buffer_load_dword v20, v21, s[80:83], s60 offen
    s_branch mpn_54
mp2_53:
    s_sub_u32 s60, s60, 270
    s_lshl_b32 s60, s60, 13
    buffer_load_dword v20, v21, s[84:87], s60 offen
mpn_54:
    s_cmp_lg_u32 s54, 0
    s_cbranch_scc1 mpb_55
    s_mov_b32 s80, s14
    s_mov_b32 s81, s15
    s_mov_b32 s82, 0xd80
    s_mov_b32 s83, 0x00020000
    buffer_load_dword v20, v21, s[80:83], 0 offen
    s_mov_b32 s80, s18
    s_mov_b32 s81, s19
    s_mov_b32 s82, 0x500
    s_mov_b32 s83, 0x00020000
    buffer_load_dword v20, v21, s[80:83], 0 offen
mpb_55:
    s_waitcnt vmcnt(0)
L_p2:
    s_lshl_b32 s60, s54, 2
    s_lshr_b32 s79, 0x30214756, s60
    s_and_b32 s79, s79, 7
    v_lshlrev_b32 v3, 3, v0
    v_mov_b32 v4, 0x00003f80
    v_mov_b32 v5, 0
    v_add_u32 v3, 143680, v3
    ds_write_b64 v3, v[4:5]
    v_mov_b32 v3, 161796
    ds_write_b32 v3, v5
    v_lshlrev_b32 v151, 4, v2
    v_and_b32 v3, 31, v2
    v_lshrrev_b32 v4, 5, v2
    v_mul_u32_u24 v5, 8256, v4
    v_lshlrev_b32 v6, 3, v3
    v_add_u32 v5, v5, v6
    v_add_u32 v148, 102400, v5
    v_add_u32 v149, 118912, v6
    v_and_b32 v5, 15, v2
    v_lshrrev_b32 v6, 2, v5
    v_and_b32 v5, 3, v5
    v_lshrrev_b32 v7, 4, v2
    v_and_b32 v7, 1, v7
    v_min_u32 v8, 1, v5
    v_add_u32 v8, 4, v8
    v_cmp_eq_u32 vcc, 1, v7
    s_nop 1
    v_cndmask_b32 v5, v5, v8, vcc
    v_mul_u32_u24 v5, 4128, v5
    v_lshlrev_b32 v7, 2, v4
    v_add_u32 v6, v6, v7
    v_lshlrev_b32 v6, 3, v6
    v_add_u32 v5, v5, v6
    v_add_u32 v150, 123040, v5
    v_and_b32 v5, 1, v3
    v_lshlrev_b32 v5, 4, v5
    v_lshrrev_b32 v6, 1, v3
    v_add_u32 v5, v5, v6
    v_lshlrev_b32 v6, 1, v4
    v_sub_u32 v147, v5, v6
    v_mov_b32 v5, 0xf149f2ca
    v_cmp_le_i32 vcc, 0, v147
    s_nop 1
    v_cndmask_b32_e64 v112, v5, 0, vcc
    v_cndmask_b32_e64 v96, 0, v5, vcc
    v_mov_b32 v128, 0
    v_cmp_le_i32 vcc, 16, v147
    s_nop 1
    v_cndmask_b32_e64 v113, v5, 0, vcc
    v_cndmask_b32_e64 v97, 0, v5, vcc
    v_mov_b32 v129, 0
    v_cmp_le_i32 vcc, 1, v147
    s_nop 1
    v_cndmask_b32_e64 v114, v5, 0, vcc
    v_cndmask_b32_e64 v98, 0, v5, vcc
    v_mov_b32 v130, 0
    v_cmp_le_i32 vcc, 17, v147
    s_nop 1
    v_cndmask_b32_e64 v115, v5, 0, vcc
    v_cndmask_b32_e64 v99, 0, v5, vcc
    v_mov_b32 v131, 0
    v_cmp_le_i32 vcc, 4, v147
    s_nop 1
    v_cndmask_b32_e64 v116, v5, 0, vcc
    v_cndmask_b32_e64 v100, 0, v5, vcc
    v_mov_b32 v132, 0
    v_cmp_le_i32 vcc, 20, v147
    s_nop 1
    v_cndmask_b32_e64 v117, v5, 0, vcc
    v_cndmask_b32_e64 v101, 0, v5, vcc
    v_mov_b32 v133, 0
    v_cmp_le_i32 vcc, 5, v147
    s_nop 1
    v_cndmask_b32_e64 v118, v5, 0, vcc
    v_cndmask_b32_e64 v102, 0, v5, vcc
    v_mov_b32 v134, 0
    v_cmp_le_i32 vcc, 21, v147
    s_nop 1
    v_cndmask_b32_e64 v119, v5, 0, vcc
    v_cndmask_b32_e64 v103, 0, v5, vcc
    v_mov_b32 v135, 0
    v_cmp_le_i32 vcc, 8, v147
    s_nop 1
    v_cndmask_b32_e64 v120, v5, 0, vcc
    v_cndmask_b32_e64 v104, 0, v5, vcc
    v_mov_b32 v136, 0
    v_cmp_le_i32 vcc, 24, v147
    s_nop 1
    v_cndmask_b32_e64 v121, v5, 0, vcc
    v_cndmask_b32_e64 v105, 0, v5, vcc
    v_mov_b32 v137, 0
    v_cmp_le_i32 vcc, 9, v147
    s_nop 1
    v_cndmask_b32_e64 v122, v5, 0, vcc
    v_cndmask_b32_e64 v106, 0, v5, vcc
    v_mov_b32 v138, 0
    v_cmp_le_i32 vcc, 25, v147
    s_nop 1
    v_cndmask_b32_e64 v123, v5, 0, vcc
    v_cndmask_b32_e64 v107, 0, v5, vcc
    v_mov_b32 v139, 0
    v_cmp_le_i32 vcc, 12, v147
    s_nop 1
    v_cndmask_b32_e64 v124, v5, 0, vcc
    v_cndmask_b32_e64 v108, 0, v5, vcc
    v_mov_b32 v140, 0
    v_cmp_le_i32 vcc, 28, v147
    s_nop 1
    v_cndmask_b32_e64 v125, v5, 0, vcc
    v_cndmask_b32_e64 v109, 0, v5, vcc
    v_mov_b32 v141, 0
    v_cmp_le_i32 vcc, 13, v147
    s_nop 1
    v_cndmask_b32_e64 v126, v5, 0, vcc
    v_cndmask_b32_e64 v110, 0, v5, vcc
    v_mov_b32 v142, 0
    v_cmp_le_i32 vcc, 29, v147
    s_nop 1
    v_cndmask_b32_e64 v127, v5, 0, vcc
    v_cndmask_b32_e64 v111, 0, v5, vcc
    v_mov_b32 v143, 0
    v_mov_b32 v62, 0
    v_mov_b32 v63, 0
    v_mov_b32 v94, 0
    v_mov_b32 v95, 0
    s_mul_i32 s64, s52, 0x100000
    s_add_u32 s64, s64, 0x100000
    s_mul_i32 s60, s53, 10240
    s_add_u32 s64, s64, s60
    s_mul_i32 s69, s52, 0x100000
    s_add_u32 s69, s69, 0x150000
    s_mul_i32 s60, s53, 10240
    s_add_u32 s69, s69, s60
    s_add_u32 s65, s54, 0
    s_cmp_ge_u32 s65, 10
    s_cselect_b32 s66, 1, 0
    s_mul_i32 s60, s66, 10
    s_sub_u32 s67, s65, s60
    s_lshr_b32 s68, s67, 1
    s_and_b32 s67, s67, 1
    s_mul_i32 s60, s66, 327680
    s_lshl_b32 s61, s68, 11
    s_add_u32 s60, s60, s61
    s_lshl_b32 s61, s67, 10
    s_add_u32 s60, s60, s61
    s_add_u32 s84, s60, s69
    s_mul_i32 s62, s66, 20640
    s_mul_i32 s63, s68, 4128
    s_add_u32 s62, s62, s63
    s_add_u32 s62, s62, s61
    s_add_u32 s85, s62, 104448
    s_add_u32 s65, s54, 8
    s_cmp_ge_u32 s65, 10
    s_cselect_b32 s66, 1, 0
    s_mul_i32 s60, s66, 10
    s_sub_u32 s67, s65, s60
    s_lshr_b32 s68, s67, 1
    s_and_b32 s67, s67, 1
    s_mul_i32 s60, s66, 327680
    s_lshl_b32 s61, s68, 11
    s_add_u32 s60, s60, s61
    s_lshl_b32 s61, s67, 10
    s_add_u32 s60, s60, s61
    s_add_u32 s86, s60, s69
    s_mul_i32 s62, s66, 20640
    s_mul_i32 s63, s68, 4128
    s_add_u32 s62, s62, s63
    s_add_u32 s62, s62, s61
    s_add_u32 s87, s62, 104448
    s_add_u32 s65, s54, 16
    s_cmp_ge_u32 s65, 10
    s_cselect_b32 s66, 1, 0
    s_mul_i32 s60, s66, 10
    s_sub_u32 s67, s65, s60
    s_lshr_b32 s68, s67, 1
    s_and_b32 s67, s67, 1
    s_mul_i32 s60, s66, 327680
    s_lshl_b32 s61, s68, 11
    s_add_u32 s60, s60, s61
    s_lshl_b32 s61, s67, 10
    s_add_u32 s60, s60, s61
    s_add_u32 s88, s60, s69
    s_mul_i32 s62, s66, 20640
    s_mul_i32 s63, s68, 4128
    s_add_u32 s62, s62, s63
    s_add_u32 s62, s62, s61
    s_add_u32 s89, s62, 104448
    s_lshl_b32 s60, s79, 8
    s_add_u32 s90, s64, s60
    v_lshlrev_b32 v152, 3, v3
    v_lshlrev_b32 v153, 12, v4
    v_add_u32 v153, v153, v152
    s_lshr_b32 s77, s53, 2
    s_mul_i32 s77, s77, 102400
    s_add_u32 s77, s77, 0x2000000
    s_lshl_b32 s76, s54, 10
    s_waitcnt lgkmcnt(0)
    s_cmp_lg_u32 s54, 6
    s_cbranch_scc1 L_p2_a
    s_cmp_lt_u32 s53, 30
    s_cbranch_scc1 tq_56
    s_mov_b32 s66, 0x3fffffff
    s_mov_b32 s67, 0
    s_mov_b32 s92, 0
poll_57:
    buffer_load_dword v243, v240, s[36:39], s3 offen sc1
pollc_59:
    s_waitcnt vmcnt(0)
    v_cmp_gt_u32 vcc, 2, v243
    s_nop 2
    s_and_b64 vcc, vcc, s[66:67]
    s_cbranch_vccz polld_58
    s_sleep 8
    s_add_u32 s92, s92, 1
    s_cmp_lt_u32 s92, 0x40000
    s_cbranch_scc1 poll_57
polld_58:
    s_cmp_eq_u32 s55, 0
    s_cbranch_scc1 acq_60
    buffer_inv sc1
    s_waitcnt vmcnt(0)
acq_60:
    v_lshlrev_b32 v3, 2, v2
    s_mov_b32 s92, 0
arr_61:
    buffer_load_dword v20, v3, s[44:47], 0 offen sc1
    s_waitcnt vmcnt(0)
    v_and_b32 v5, 0x80808080, v20
    v_cmp_ne_u32 vcc, 0x80808080, v5
    s_cbranch_vccz arrd_62
    s_sleep 48
    s_add_u32 s92, s92, 1
    s_cmp_lt_u32 s92, 0x20000
    s_cbranch_scc1 arr_61
arrd_62:
    s_getreg_b32 s60, hwreg(HW_REG_XCC_ID)
    s_and_b32 s60, s60, 15
    s_or_b32 s60, s60, 0x80
    s_mul_i32 s60, s60, 0x01010101
    v_cmp_ne_u32 vcc, s60, v20
    s_mov_b64 s[60:61], 0xff
    s_lshl_b32 s62, s52, 3
    s_lshl_b64 s[60:61], s[60:61], s62
    s_and_b64 s[60:61], s[60:61], vcc
    s_cmp_lg_u64 s[60:61], 0
    s_cselect_b32 s55, 1, 0
tq_56:
    s_mov_b32 s92, 0
poll_63:
    buffer_load_dword v243, v240, s[36:39], s3 offen sc1
pollc_65:
    s_waitcnt vmcnt(0)
    v_cmp_gt_u32 vcc, 2, v243
    s_cbranch_vccz polld_64
    s_add_u32 s92, s92, 1
    s_cmp_lt_u32 s92, 0x40000
    s_cbranch_scc1 poll_63
polld_64:
    s_cmp_eq_u32 s55, 0
    s_cbranch_scc1 acq_66
    buffer_inv sc1
    s_waitcnt vmcnt(0)
acq_66:
L_p2_a:
    s_barrier
    s_mov_b32 m0, s85
    s_nop 0
    buffer_load_dwordx4 v151, s[36:39], s84 offen sc1 lds
kvs_67:
    s_mov_b32 m0, s87
    s_nop 0
    buffer_load_dwordx4 v151, s[36:39], s86 offen sc1 lds
kvs_68:
    s_cmp_ge_u32 s54, 4
    s_cbranch_scc1 kvs_69
    s_mov_b32 m0, s89
    s_nop 0
    buffer_load_dwordx4 v151, s[36:39], s88 offen sc1 lds
kvs_69:
    buffer_load_dwordx2 v[88:89], v153, s[36:39], s90 offen
    buffer_load_dwordx2 v[90:91], v153, s[36:39], s90 offen offset:2048
    s_add_u32 s60, s90, 8192
    buffer_load_dwordx2 v[92:93], v152, s[36:39], s60 offen
    s_mov_b32 s78, 1
    s_cmp_lg_u32 s54, 6
    s_cbranch_scc1 xe_70
    s_cmp_eq_u32 s52, 0
    s_cbranch_scc1 xe_70
    s_sub_u32 s66, s52, 1
    s_lshl_b32 s66, s66, 9
    s_add_u32 s66, s66, 0x1000
    s_add_u32 s67, s66, 256
    v_lshlrev_b32 v6, 2, v2
    v_and_b32 v5, 15, v2
    v_lshlrev_b32 v5, 2, v5
    buffer_load_dword v10, v6, s[36:39], s66 offen sc1
    buffer_load_dword v11, v5, s[36:39], s67 offen sc1
    s_waitcnt vmcnt(0)
    v_min_u32 v10, v10, v11
    v_cmp_gt_u32 vcc, 1, v10
    s_mov_b32 s78, 0
    s_cbranch_vccnz xe2_71
    s_sub_u32 s64, s52, 1
    s_mul_i32 s64, s64, 0x100000
    s_add_u32 s64, s64, 0x150000
    s_mul_i32 s60, s53, 10240
    s_add_u32 s64, s64, s60
    s_mov_b32 m0, 102400
    s_add_u32 s60, s64, 0
    buffer_load_dwordx4 v151, s[36:39], s60 offen sc1 lds
    s_mov_b32 m0, 103424
    s_add_u32 s60, s64, 1024
    buffer_load_dwordx4 v151, s[36:39], s60 offen sc1 lds
    s_mov_b32 m0, 106528
    s_add_u32 s60, s64, 2048
    buffer_load_dwordx4 v151, s[36:39], s60 offen sc1 lds
    s_mov_b32 m0, 107552
    s_add_u32 s60, s64, 3072
    buffer_load_dwordx4 v151, s[36:39], s60 offen sc1 lds
    s_mov_b32 m0, 110656
    s_add_u32 s60, s64, 4096
    buffer_load_dwordx4 v151, s[36:39], s60 offen sc1 lds
    s_mov_b32 m0, 111680
    s_add_u32 s60, s64, 5120
    buffer_load_dwordx4 v151, s[36:39], s60 offen sc1 lds
    s_mov_b32 m0, 114784
    s_add_u32 s60, s64, 6144
    buffer_load_dwordx4 v151, s[36:39], s60 offen sc1 lds
    s_mov_b32 m0, 115808
    s_add_u32 s60, s64, 7168
    buffer_load_dwordx4 v151, s[36:39], s60 offen sc1 lds
    s_mov_b32 m0, 118912
    s_add_u32 s60, s64, 8192
    buffer_load_dwordx4 v151, s[36:39], s60 offen sc1 lds
    s_mov_b32 m0, 119936
    s_add_u32 s60, s64, 9216
    buffer_load_dwordx4 v151, s[36:39], s60 offen sc1 lds
    s_mov_b32 m0, 123040
    s_add_u32 s60, s64, 327680
    buffer_load_dwordx4 v151, s[36:39], s60 offen sc1 lds
    s_mov_b32 m0, 124064
    s_add_u32 s60, s64, 328704
    buffer_load_dwordx4 v151, s[36:39], s60 offen sc1 lds
    s_mov_b32 m0, 127168
    s_add_u32 s60, s64, 329728
    buffer_load_dwordx4 v151, s[36:39], s60 offen sc1 lds
    s_mov_b32 m0, 128192
    s_add_u32 s60, s64, 330752
    buffer_load_dwordx4 v151, s[36:39], s60 offen sc1 lds
    s_mov_b32 m0, 131296
    s_add_u32 s60, s64, 331776
    buffer_load_dwordx4 v151, s[36:39], s60 offen sc1 lds
    s_mov_b32 m0, 132320
    s_add_u32 s60, s64, 332800
    buffer_load_dwordx4 v151, s[36:39], s60 offen sc1 lds
    s_mov_b32 m0, 135424
    s_add_u32 s60, s64, 333824
    buffer_load_dwordx4 v151, s[36:39], s60 offen sc1 lds
    s_mov_b32 m0, 136448
    s_add_u32 s60, s64, 334848
    buffer_load_dwordx4 v151, s[36:39], s60 offen sc1 lds
    s_mov_b32 m0, 139552
    s_add_u32 s60, s64, 335872
    buffer_load_dwordx4 v151, s[36:39], s60 offen sc1 lds
    s_mov_b32 m0, 140576
    s_add_u32 s60, s64, 336896
    buffer_load_dwordx4 v151, s[36:39], s60 offen sc1 lds
    s_mov_b32 s78, 1
    s_barrier
    s_branch xe3_72
xe_70:
    s_waitcnt vmcnt(0)
xe2_71:
    s_barrier
xe3_72:
    s_cmp_lg_u32 s78, 0
    s_cbranch_scc1 p2h_73
    s_sub_u32 s66, s52, 1
    s_lshl_b32 s66, s66, 9
    s_add_u32 s66, s66, 0x1000
    s_add_u32 s67, s66, 256
    v_lshlrev_b32 v6, 2, v2
    v_and_b32 v5, 15, v2
    v_lshlrev_b32 v5, 2, v5
    s_mov_b32 s92, 0
xf_74:
    buffer_load_dword v10, v6, s[36:39], s66 offen sc1
    buffer_load_dword v11, v5, s[36:39], s67 offen sc1
    s_waitcnt vmcnt(0)
    v_min_u32 v10, v10, v11
    v_cmp_gt_u32 vcc, 1, v10
    s_cbranch_vccz xfd_75
    s_sleep 8
    s_add_u32 s92, s92, 1
    s_cmp_lt_u32 s92, 0x40000
    s_cbranch_scc1 xf_74
xfd_75:
    s_sub_u32 s64, s52, 1
    s_mul_i32 s64, s64, 0x100000
    s_add_u32 s64, s64, 0x150000
    s_mul_i32 s60, s53, 10240
    s_add_u32 s64, s64, s60
    s_mov_b32 m0, 102400
    s_add_u32 s60, s64, 0
    buffer_load_dwordx4 v151, s[36:39], s60 offen sc1 lds
    s_mov_b32 m0, 103424
    s_add_u32 s60, s64, 1024
    buffer_load_dwordx4 v151, s[36:39], s60 offen sc1 lds
    s_mov_b32 m0, 106528
    s_add_u32 s60, s64, 2048
    buffer_load_dwordx4 v151, s[36:39], s60 offen sc1 lds
    s_mov_b32 m0, 107552
    s_add_u32 s60, s64, 3072
    buffer_load_dwordx4 v151, s[36:39], s60 offen sc1 lds
    s_mov_b32 m0, 110656
    s_add_u32 s60, s64, 4096
    buffer_load_dwordx4 v151, s[36:39], s60 offen sc1 lds
    s_mov_b32 m0, 111680
    s_add_u32 s60, s64, 5120
    buffer_load_dwordx4 v151, s[36:39], s60 offen sc1 lds
    s_mov_b32 m0, 114784
    s_add_u32 s60, s64, 6144
    buffer_load_dwordx4 v151, s[36:39], s60 offen sc1 lds
    s_mov_b32 m0, 115808
    s_add_u32 s60, s64, 7168
    buffer_load_dwordx4 v151, s[36:39], s60 offen sc1 lds
    s_mov_b32 m0, 118912
    s_add_u32 s60, s64, 8192
    buffer_load_dwordx4 v151, s[36:39], s60 offen sc1 lds
    s_mov_b32 m0, 119936
    s_add_u32 s60, s64, 9216
    buffer_load_dwordx4 v151, s[36:39], s60 offen sc1 lds
    s_mov_b32 m0, 123040
    s_add_u32 s60, s64, 327680
    buffer_load_dwordx4 v151, s[36:39], s60 offen sc1 lds
    s_mov_b32 m0, 124064
    s_add_u32 s60, s64, 328704
    buffer_load_dwordx4 v151, s[36:39], s60 offen sc1 lds
    s_mov_b32 m0, 127168
    s_add_u32 s60, s64, 329728
    buffer_load_dwordx4 v151, s[36:39], s60 offen sc1 lds
    s_mov_b32 m0, 128192
    s_add_u32 s60, s64, 330752
    buffer_load_dwordx4 v151, s[36:39], s60 offen sc1 lds
    s_mov_b32 m0, 131296
    s_add_u32 s60, s64, 331776
    buffer_load_dwordx4 v151, s[36:39], s60 offen sc1 lds
    s_mov_b32 m0, 132320
    s_add_u32 s60, s64, 332800
    buffer_load_dwordx4 v151, s[36:39], s60 offen sc1 lds
    s_mov_b32 m0, 135424
    s_add_u32 s60, s64, 333824
    buffer_load_dwordx4 v151, s[36:39], s60 offen sc1 lds
    s_mov_b32 m0, 136448
    s_add_u32 s60, s64, 334848
    buffer_load_dwordx4 v151, s[36:39], s60 offen sc1 lds
    s_mov_b32 m0, 139552
    s_add_u32 s60, s64, 335872
    buffer_load_dwordx4 v151, s[36:39], s60 offen sc1 lds
    s_mov_b32 m0, 140576
    s_add_u32 s60, s64, 336896
    buffer_load_dwordx4 v151, s[36:39], s60 offen sc1 lds
p2h_73:
    v_cmp_gt_u32 vcc, 32, v2
    s_nop 1
    v_cndmask_b32 v92, 0, v92, vcc
    v_cndmask_b32 v93, 0, v93, vcc
    v_mov_b32 v154, 0
    s_mov_b32 s72, 0
att_redo_76:
    v_mov_b32 v72, 0
    v_mov_b32 v73, 0
    v_mov_b32 v74, 0
    v_mov_b32 v75, 0
    v_mov_b32 v76, 0
    v_mov_b32 v77, 0
    v_mov_b32 v78, 0
    v_mov_b32 v79, 0
    v_mov_b32 v80, 0
    v_mov_b32 v81, 0
    v_mov_b32 v82, 0
    v_mov_b32 v83, 0
    v_mov_b32 v84, 0
    v_mov_b32 v85, 0
    v_mov_b32 v86, 0
    v_mov_b32 v87, 0
    s_mov_b32 s70, 8
    s_add_u32 s71, s79, 1
    s_mov_b32 s74, 1
    s_mov_b32 s81, 0
att_pass_80:
    s_lshl_b32 s60, s70, 8
    v_add_u32 v144, s60, v148
    v_add_u32 v145, s60, v149
    v_add_u32 v146, s60, v150
    ds_read_b64 v[56:57], v144 offset:0
    ds_read_b64 v[58:59], v144 offset:4128
    ds_read_b64 v[60:61], v145 offset:0
    v_mov_b32 v128, v154
    v_mov_b32 v129, v154
    v_mov_b32 v130, v154
    v_mov_b32 v131, v154
    v_mov_b32 v132, v154
    v_mov_b32 v133, v154
    v_mov_b32 v134, v154
    v_mov_b32 v135, v154
    v_mov_b32 v136, v154
    v_mov_b32 v137, v154
    v_mov_b32 v138, v154
    v_mov_b32 v139, v154
    v_mov_b32 v140, v154
    v_mov_b32 v141, v154
    v_mov_b32 v142, v154
    v_mov_b32 v143, v154
    v_mov_b32 v64, 0
    v_mov_b32 v176, 0
    v_mov_b32 v65, 0
    v_mov_b32 v177, 0
    v_mov_b32 v66, 0
    v_mov_b32 v178, 0
    v_mov_b32 v67, 0
    v_mov_b32 v179, 0
    v_mov_b32 v68, 0
    v_mov_b32 v180, 0
    v_mov_b32 v69, 0
    v_mov_b32 v181, 0
    v_mov_b32 v70, 0
    v_mov_b32 v182, 0
    v_mov_b32 v71, 0
    v_mov_b32 v183, 0
    s_waitcnt lgkmcnt(0)
    s_cmp_eq_u32 s74, 0
    s_cbranch_scc1 c1_81
    s_cmp_eq_u32 s71, 1
    s_cbranch_scc1 c2_82
    v_mfma_f32_32x32x16_bf16 v[16:31], v[56:59], v[88:91], v[128:143]
    s_branch c3_83
c1_81:
    v_mfma_f32_32x32x16_bf16 v[16:31], v[56:59], v[88:91], v[96:111]
    s_branch c3_83
c2_82:
    v_mfma_f32_32x32x16_bf16 v[16:31], v[56:59], v[88:91], v[112:127]
c3_83:
    v_mfma_f32_32x32x16_bf16 v[16:31], v[60:63], v[92:95], v[16:31]
    ds_read_b64 v[56:57], v144 offset:256
    ds_read_b64 v[58:59], v144 offset:4384
    ds_read_b64 v[60:61], v145 offset:256
    s_sub_u32 s73, s71, 1
    s_waitcnt lgkmcnt(0)
    s_nop 7
att_A_84:
    s_cmp_eq_u32 s73, 0
    s_cbranch_scc1 att_FA_86
    s_cmp_eq_u32 s73, s74
    s_cbranch_scc1 ml_89
mlb_90:
    s_waitcnt lgkmcnt(4)
    v_mfma_f32_32x32x16_bf16 v[160:175], v[56:59], v[88:91], v[128:143]
    v_exp_f32 v32, v16
    v_exp_f32 v33, v17
    v_exp_f32 v34, v18
    v_exp_f32 v35, v19
    v_mfma_f32_32x32x16_bf16 v[160:175], v[60:63], v[92:95], v[160:175]
    v_exp_f32 v36, v20
    v_exp_f32 v37, v21
    v_exp_f32 v38, v22
    v_exp_f32 v39, v23
    s_waitcnt lgkmcnt(0)
    v_mfma_f32_32x32x16_bf16 v[72:87], v[64:67], v[176:179], v[72:87]
    ds_read_b64 v[56:57], v144 offset:512
    ds_read_b64 v[58:59], v144 offset:4640
    ds_read_b64 v[60:61], v145 offset:512
    v_exp_f32 v40, v24
    v_exp_f32 v41, v25
    v_exp_f32 v42, v26
    v_exp_f32 v43, v27
    v_mfma_f32_32x32x16_bf16 v[72:87], v[68:71], v[180:183], v[72:87]
    v_exp_f32 v44, v28
    v_exp_f32 v45, v29
    v_exp_f32 v46, v30
    v_exp_f32 v47, v31
    ds_read_b64_tr_b16 v[64:65], v146 offset:0
    ds_read_b64_tr_b16 v[66:67], v146 offset:64
    ds_read_b64_tr_b16 v[68:69], v146 offset:128
    ds_read_b64_tr_b16 v[70:71], v146 offset:192
    v_cvt_pk_bf16_f32 v48, v32, v33
    v_cvt_pk_bf16_f32 v49, v34, v35
    v_cvt_pk_bf16_f32 v50, v36, v37
    v_cvt_pk_bf16_f32 v51, v38, v39
    v_cvt_pk_bf16_f32 v52, v40, v41
    v_cvt_pk_bf16_f32 v53, v42, v43
    v_cvt_pk_bf16_f32 v54, v44, v45
    v_cvt_pk_bf16_f32 v55, v46, v47
    v_add_u32 v144, 256, v144
    v_add_u32 v145, 256, v145
    v_add_u32 v146, 256, v146
    s_sub_u32 s73, s73, 1
    s_cmp_eq_u32 s73, 0
    s_cbranch_scc1 att_FB_87
    s_cmp_eq_u32 s73, s74
    s_cbranch_scc1 ml_91
mlb_92:
    s_waitcnt lgkmcnt(4)
    v_mfma_f32_32x32x16_bf16 v[16:31], v[56:59], v[88:91], v[128:143]
    v_exp_f32 v32, v160
    v_exp_f32 v33, v161
    v_exp_f32 v34, v162
    v_exp_f32 v35, v163
    v_mfma_f32_32x32x16_bf16 v[16:31], v[60:63], v[92:95], v[16:31]
    v_exp_f32 v36, v164
    v_exp_f32 v37, v165
    v_exp_f32 v38, v166
    v_exp_f32 v39, v167
    s_waitcnt lgkmcnt(0)
    v_mfma_f32_32x32x16_bf16 v[72:87], v[64:67], v[48:51], v[72:87]
    ds_read_b64 v[56:57], v144 offset:512
    ds_read_b64 v[58:59], v144 offset:4640
    ds_read_b64 v[60:61], v145 offset:512
    v_exp_f32 v40, v168
    v_exp_f32 v41, v169
    v_exp_f32 v42, v170
    v_exp_f32 v43, v171
    v_mfma_f32_32x32x16_bf16 v[72:87], v[68:71], v[52:55], v[72:87]
    v_exp_f32 v44, v172
    v_exp_f32 v45, v173
    v_exp_f32 v46, v174
    v_exp_f32 v47, v175
    ds_read_b64_tr_b16 v[64:65], v146 offset:0
    ds_read_b64_tr_b16 v[66:67], v146 offset:64
    ds_read_b64_tr_b16 v[68:69], v146 offset:128
    ds_read_b64_tr_b16 v[70:71], v146 offset:192
    v_cvt_pk_bf16_f32 v176, v32, v33
    v_cvt_pk_bf16_f32 v177, v34, v35
    v_cvt_pk_bf16_f32 v178, v36, v37
    v_cvt_pk_bf16_f32 v179, v38, v39
    v_cvt_pk_bf16_f32 v180, v40, v41
    v_cvt_pk_bf16_f32 v181, v42, v43
    v_cvt_pk_bf16_f32 v182, v44, v45
    v_cvt_pk_bf16_f32 v183, v46, v47
    v_add_u32 v144, 256, v144
    v_add_u32 v145, 256, v145
    v_add_u32 v146, 256, v146
    s_sub_u32 s73, s73, 1
    s_branch att_A_84
ml_89:
    v_mov_b32 v128, v112
    v_mov_b32 v129, v113
    v_mov_b32 v130, v114
    v_mov_b32 v131, v115
    v_mov_b32 v132, v116
    v_mov_b32 v133, v117
    v_mov_b32 v134, v118
    v_mov_b32 v135, v119
    v_mov_b32 v136, v120
    v_mov_b32 v137, v121
    v_mov_b32 v138, v122
    v_mov_b32 v139, v123
    v_mov_b32 v140, v124
    v_mov_b32 v141, v125
    v_mov_b32 v142, v126
    v_mov_b32 v143, v127
    s_branch mlb_90
ml_91:
    v_mov_b32 v128, v112
    v_mov_b32 v129, v113
    v_mov_b32 v130, v114
    v_mov_b32 v131, v115
    v_mov_b32 v132, v116
    v_mov_b32 v133, v117
    v_mov_b32 v134, v118
    v_mov_b32 v135, v119
    v_mov_b32 v136, v120
    v_mov_b32 v137, v121
    v_mov_b32 v138, v122
    v_mov_b32 v139, v123
    v_mov_b32 v140, v124
    v_mov_b32 v141, v125
    v_mov_b32 v142, v126
    v_mov_b32 v143, v127
    s_branch mlb_92
att_FA_86:
    v_exp_f32 v32, v16
    v_exp_f32 v33, v17
    v_exp_f32 v34, v18
    v_exp_f32 v35, v19
    v_exp_f32 v36, v20
    v_exp_f32 v37, v21
    v_exp_f32 v38, v22
    v_exp_f32 v39, v23
    s_waitcnt lgkmcnt(0)
    v_mfma_f32_32x32x16_bf16 v[72:87], v[64:67], v[176:179], v[72:87]
    v_exp_f32 v40, v24
    v_exp_f32 v41, v25
    v_exp_f32 v42, v26
    v_exp_f32 v43, v27
    v_mfma_f32_32x32x16_bf16 v[72:87], v[68:71], v[180:183], v[72:87]
    v_exp_f32 v44, v28
    v_exp_f32 v45, v29
    v_exp_f32 v46, v30
    v_exp_f32 v47, v31
    ds_read_b64_tr_b16 v[64:65], v146 offset:0
    ds_read_b64_tr_b16 v[66:67], v146 offset:64
    ds_read_b64_tr_b16 v[68:69], v146 offset:128
    ds_read_b64_tr_b16 v[70:71], v146 offset:192
    v_cvt_pk_bf16_f32 v48, v32, v33
    v_cvt_pk_bf16_f32 v49, v34, v35
    v_cvt_pk_bf16_f32 v50, v36, v37
    v_cvt_pk_bf16_f32 v51, v38, v39
    v_cvt_pk_bf16_f32 v52, v40, v41
    v_cvt_pk_bf16_f32 v53, v42, v43
    v_cvt_pk_bf16_f32 v54, v44, v45
    v_cvt_pk_bf16_f32 v55, v46, v47
    s_waitcnt lgkmcnt(0)
    v_mfma_f32_32x32x16_bf16 v[72:87], v[64:67], v[48:51], v[72:87]
    v_mfma_f32_32x32x16_bf16 v[72:87], v[68:71], v[52:55], v[72:87]
    s_branch att_pd_88
att_FB_87:
    v_exp_f32 v32, v160
    v_exp_f32 v33, v161
    v_exp_f32 v34, v162
    v_exp_f32 v35, v163
    v_exp_f32 v36, v164
    v_exp_f32 v37, v165
    v_exp_f32 v38, v166
    v_exp_f32 v39, v167
    s_waitcnt lgkmcnt(0)
    v_mfma_f32_32x32x16_bf16 v[72:87], v[64:67], v[48:51], v[72:87]
    v_exp_f32 v40, v168
    v_exp_f32 v41, v169
    v_exp_f32 v42, v170
    v_exp_f32 v43, v171
    v_mfma_f32_32x32x16_bf16 v[72:87], v[68:71], v[52:55], v[72:87]
    v_exp_f32 v44, v172
    v_exp_f32 v45, v173
    v_exp_f32 v46, v174
    v_exp_f32 v47, v175
    ds_read_b64_tr_b16 v[64:65], v146 offset:0
    ds_read_b64_tr_b16 v[66:67], v146 offset:64
    ds_read_b64_tr_b16 v[68:69], v146 offset:128
    ds_read_b64_tr_b16 v[70:71], v146 offset:192
    v_cvt_pk_bf16_f32 v176, v32, v33
    v_cvt_pk_bf16_f32 v177, v34, v35
    v_cvt_pk_bf16_f32 v178, v36, v37
    v_cvt_pk_bf16_f32 v179, v38, v39
    v_cvt_pk_bf16_f32 v180, v40, v41
    v_cvt_pk_bf16_f32 v181, v42, v43
    v_cvt_pk_bf16_f32 v182, v44, v45
    v_cvt_pk_bf16_f32 v183, v46, v47
    s_waitcnt lgkmcnt(0)
    v_mfma_f32_32x32x16_bf16 v[72:87], v[64:67], v[176:179], v[72:87]
    v_mfma_f32_32x32x16_bf16 v[72:87], v[68:71], v[180:183], v[72:87]
att_pd_88:
    s_cmp_eq_u32 s74, 0
    s_cbranch_scc1 att_nh_78
    s_cmp_lg_u32 s72, 0
    s_cbranch_scc1 att_nb_79
    s_cmp_lg_u32 s54, 6
    s_cbranch_scc1 hw_93
    s_mov_b32 s65, 0x2000
    buffer_load_dwordx4 v[156:159], v151, s[36:39], s65 offen sc1
    s_waitcnt vmcnt(0)
    s_cmp_eq_u32 s52, 0
    s_cbranch_scc1 hf_94
    s_sub_u32 s60, s52, 1
    s_lshl_b32 s60, s60, 8
    s_lshl_b32 s61, s53, 2
    s_add_u32 s60, s60, s61
    s_add_u32 s60, s60, 0x3000
    v_mov_b32 v3, 1
    v_mov_b32 v4, 0
    s_mov_b64 exec, 1
    buffer_store_dword v3, v4, s[36:39], s60 offen sc0 sc1
    s_mov_b64 exec, -1
hf_94:
    s_mov_b32 s92, 0
rfl_95:
    v_min_u32 v156, v156, v157
    v_min_u32 v158, v158, v159
    v_min_u32 v156, v156, v158
    v_cmp_gt_u32 vcc, 1, v156
    s_cbranch_vccz rfo_96
    s_sleep 8
    buffer_load_dwordx4 v[156:159], v151, s[36:39], s65 offen sc1
    s_waitcnt vmcnt(0)
    s_add_u32 s92, s92, 1
    s_cmp_lt_u32 s92, 0x40000
    s_cbranch_scc1 rfl_95
rfo_96:
    v_mov_b32 v3, 161796
    v_mov_b32 v4, 1
    ds_write_b32 v3, v4
    s_waitcnt lgkmcnt(0)
    s_branch hw2_97
hw_93:
    v_mov_b32 v3, 161796
    s_mov_b32 s92, 0
hp_98:
    ds_read_b32 v4, v3
    s_waitcnt lgkmcnt(0)
    v_readfirstlane_b32 s60, v4
    s_add_u32 s92, s92, 1
    s_cmp_ge_u32 s92, 0x400000
    s_cbranch_scc1 hw2_97
    s_cmp_lg_u32 s60, 0
    s_cbranch_scc1 hw2_97
    s_sleep 1
    s_branch hp_98
hw2_97:
    s_cmp_ge_u32 s54, 4
    s_cbranch_scc1 p2b_99
wo_100:
    s_mov_b32 m0, s76
    s_add_u32 s60, s77, s76
    buffer_load_dwordx4 v151, s[36:39], s60 offen sc1 lds
    s_add_u32 s76, s76, 4096
    s_cmp_lt_u32 s76, 102400
    s_cbranch_scc1 wo_100
    v_lshrrev_b32 v204, 4, v2
    v_lshlrev_b32 v204, 3, v204
    s_mov_b32 s48, s14
    s_mov_b32 s49, s15
    s_mov_b32 s50, 0xd80
    s_mov_b32 s51, 0x00020000
    s_lshr_b32 s64, s53, 1
    s_lshl_b32 s64, s64, 8
    s_lshl_b32 s60, s59, 2
    s_lshl_b32 s61, s58, 1
    s_xor_b32 s62, s61, 0
    s_add_u32 s62, s62, s60
    s_lshl_b32 s62, s62, 5
    s_add_u32 s62, s62, s64
    buffer_load_dwordx2 v[210:211], v204, s[48:51], s62 offen
    s_xor_b32 s62, s61, 1
    s_add_u32 s62, s62, s60
    s_lshl_b32 s62, s62, 5
    s_add_u32 s62, s62, s64
    buffer_load_dwordx2 v[212:213], v204, s[48:51], s62 offen
    s_xor_b32 s62, s61, 2
    s_add_u32 s62, s62, s60
    s_lshl_b32 s62, s62, 5
    s_add_u32 s62, s62, s64
    buffer_load_dwordx2 v[214:215], v204, s[48:51], s62 offen
    s_xor_b32 s62, s61, 3
    s_add_u32 s62, s62, s60
    s_lshl_b32 s62, s62, 5
    s_add_u32 s62, s62, s64
    buffer_load_dwordx2 v[216:217], v204, s[48:51], s62 offen
    s_mov_b32 s84, s18
    s_mov_b32 s85, s19
    s_mov_b32 s86, 0x500
    s_mov_b32 s87, 0x00020000
    s_lshr_b32 s64, s53, 2
    s_and_b32 s63, s64, 1
    s_mul_i32 s64, s64, 5
    s_add_u32 s62, s63, 0
    s_add_u32 s62, s62, s64
    s_lshl_b32 s62, s62, 5
    buffer_load_dwordx2 v[218:219], v204, s[84:87], s62 offen
    s_add_u32 s62, s63, 1
    s_add_u32 s62, s62, s64
    s_lshl_b32 s62, s62, 5
    buffer_load_dwordx2 v[220:221], v204, s[84:87], s62 offen
    s_add_u32 s62, s63, 2
    s_add_u32 s62, s62, s64
    s_lshl_b32 s62, s62, 5
    buffer_load_dwordx2 v[222:223], v204, s[84:87], s62 offen
    s_add_u32 s62, s63, 3
    s_add_u32 s62, s62, s64
    s_lshl_b32 s62, s62, 5
    buffer_load_dwordx2 v[224:225], v204, s[84:87], s62 offen
    s_add_u32 s62, s63, 4
    s_cmp_eq_u32 s62, 5
    s_cselect_b32 s62, 0, s62
    s_add_u32 s62, s62, s64
    s_lshl_b32 s62, s62, 5
    buffer_load_dwordx2 v[226:227], v204, s[84:87], s62 offen
p2b_99:
att_nb_79:
    s_cmp_eq_u32 s52, 0
    s_cbranch_scc1 att_nh_78
    s_mov_b32 s70, s79
    s_sub_u32 s71, 8, s79
    s_mov_b32 s74, 0
    s_mov_b32 s81, 102400
    s_branch att_pass_80
att_nh_78:
    s_nop 7
    s_nop 3
    v_mov_b32 v3, v80
    v_mov_b32 v4, v80
    s_nop 1
    v_permlane32_swap_b32 v3, v4
    s_cmp_lg_u32 s72, 0
    s_cbranch_scc1 att_fin_77
    v_cmp_nle_f32 vcc, 0x21800000, v4
    s_nop 2
    s_mov_b64 s[60:61], vcc
    v_cmp_nge_f32 vcc, 0x5d800000, v4
    s_nop 2
    s_or_b64 vcc, vcc, s[60:61]
    s_cbranch_vccz att_fin_77
    s_mov_b32 s72, 1
    v_mov_b32 v5, 0xff61b1e6
    s_cmp_eq_u32 s52, 0
    s_cselect_b32 s70, 8, s79
    s_add_u32 s71, s79, 8
    s_lshl_b32 s60, s70, 8
    v_add_u32 v144, s60, v148
    v_add_u32 v145, s60, v149
    v_add_u32 v146, s60, v150
    v_mov_b32 v128, 0
    v_mov_b32 v129, 0
    v_mov_b32 v130, 0
    v_mov_b32 v131, 0
    v_mov_b32 v132, 0
    v_mov_b32 v133, 0
    v_mov_b32 v134, 0
    v_mov_b32 v135, 0
    v_mov_b32 v136, 0
    v_mov_b32 v137, 0
    v_mov_b32 v138, 0
    v_mov_b32 v139, 0
    v_mov_b32 v140, 0
    v_mov_b32 v141, 0
    v_mov_b32 v142, 0
    v_mov_b32 v143, 0
mx_101:
    ds_read_b64 v[56:57], v144 offset:0
    ds_read_b64 v[58:59], v144 offset:4128
    ds_read_b64 v[60:61], v145 offset:0
    s_waitcnt lgkmcnt(0)
    s_cmp_eq_u32 s70, s71
    s_cbranch_scc1 m2_103
    s_cmp_lg_u32 s70, s79
    s_cbranch_scc1 m1_102
    v_mfma_f32_32x32x16_bf16 v[16:31], v[56:59], v[88:91], v[96:111]
    s_branch m3_104
m1_102:
    v_mfma_f32_32x32x16_bf16 v[16:31], v[56:59], v[88:91], v[128:143]
    s_branch m3_104
m2_103:
    v_mfma_f32_32x32x16_bf16 v[16:31], v[56:59], v[88:91], v[112:127]
m3_104:
    v_mfma_f32_32x32x16_bf16 v[16:31], v[60:63], v[92:95], v[16:31]
    s_nop 7
    s_nop 3
    v_max_f32 v5, v5, v16
    v_max_f32 v5, v5, v17
    v_max_f32 v5, v5, v18
    v_max_f32 v5, v5, v19
    v_max_f32 v5, v5, v20
    v_max_f32 v5, v5, v21
    v_max_f32 v5, v5, v22
    v_max_f32 v5, v5, v23
    v_max_f32 v5, v5, v24
    v_max_f32 v5, v5, v25
    v_max_f32 v5, v5, v26
    v_max_f32 v5, v5, v27
    v_max_f32 v5, v5, v28
    v_max_f32 v5, v5, v29
    v_max_f32 v5, v5, v30
    v_max_f32 v5, v5, v31
    v_add_u32 v144, 256, v144
    v_add_u32 v145, 256, v145
    s_add_u32 s70, s70, 1
    s_cmp_le_u32 s70, s71
    s_cbranch_scc1 mx_101
    v_mov_b32 v6, v5
    s_nop 1
    v_permlane32_swap_b32 v5, v6
    v_max_f32 v5, v5, v6
    v_sub_f32 v154, 0, v5
    v_sub_f32 v96, v96, v5
    v_sub_f32 v112, v112, v5
    v_sub_f32 v97, v97, v5
    v_sub_f32 v113, v113, v5
    v_sub_f32 v98, v98, v5
    v_sub_f32 v114, v114, v5
    v_sub_f32 v99, v99, v5
    v_sub_f32 v115, v115, v5
    v_sub_f32 v100, v100, v5
    v_sub_f32 v116, v116, v5
    v_sub_f32 v101, v101, v5
    v_sub_f32 v117, v117, v5
    v_sub_f32 v102, v102, v5
    v_sub_f32 v118, v118, v5
    v_sub_f32 v103, v103, v5
    v_sub_f32 v119, v119, v5
    v_sub_f32 v104, v104, v5
    v_sub_f32 v120, v120, v5
    v_sub_f32 v105, v105, v5
    v_sub_f32 v121, v121, v5
    v_sub_f32 v106, v106, v5
    v_sub_f32 v122, v122, v5
    v_sub_f32 v107, v107, v5
    v_sub_f32 v123, v123, v5
    v_sub_f32 v108, v108, v5
    v_sub_f32 v124, v124, v5
    v_sub_f32 v109, v109, v5
    v_sub_f32 v125, v125, v5
    v_sub_f32 v110, v110, v5
    v_sub_f32 v126, v126, v5
    v_sub_f32 v111, v111, v5
    v_sub_f32 v127, v127, v5
    s_branch att_redo_76
att_fin_77:
    v_rcp_f32 v4, v4
    s_nop 0
    v_mul_f32 v72, v72, v4
    v_mul_f32 v73, v73, v4
    v_mul_f32 v74, v74, v4
    v_mul_f32 v75, v75, v4
    v_mul_f32 v76, v76, v4
    v_mul_f32 v77, v77, v4
    v_mul_f32 v78, v78, v4
    v_mul_f32 v79, v79, v4
    v_mul_f32 v80, v80, v4
    v_mul_f32 v81, v81, v4
    v_mul_f32 v82, v82, v4
    v_mul_f32 v83, v83, v4
    v_cvt_pk_bf16_f32 v48, v72, v73
    v_cvt_pk_bf16_f32 v49, v74, v75
    v_cvt_pk_bf16_f32 v50, v76, v77
    v_cvt_pk_bf16_f32 v51, v78, v79
    v_cvt_pk_bf16_f32 v52, v80, v81
    v_cvt_pk_bf16_f32 v53, v82, v83
    v_and_b32 v3, 31, v2
    v_lshrrev_b32 v4, 5, v2
    v_and_b32 v5, 1, v3
    v_lshrrev_b32 v6, 1, v3
    v_lshlrev_b32 v7, 9, v5
    v_lshlrev_b32 v8, 4, v6
    v_add_u32 v7, v7, v8
    v_lshlrev_b32 v4, 8, v4
    v_add_u32 v7, v7, v4
    v_lshlrev_b32 v5, 7, v5
    v_lshlrev_b32 v6, 3, v6
    v_add_u32 v5, v5, v6
    s_mul_i32 s64, s52, 0x100000
    s_add_u32 s64, s64, 0x100000
    s_mul_i32 s60, s53, 10240
    s_add_u32 s64, s64, s60
    s_lshl_b32 s60, s79, 10
    s_add_u32 s60, s60, s64
    s_lshl_b32 s62, s79, 8
    s_add_u32 s62, s62, s64
    s_add_u32 s62, s62, 8192
    buffer_store_dwordx4 v[48:51], v7, s[36:39], s60 offen
    s_mov_b32 exec_hi, 0
    buffer_store_dwordx2 v[52:53], v5, s[36:39], s62 offen
    s_mov_b64 exec, -1
    s_waitcnt vmcnt(0)
    s_barrier
    s_cmp_ge_u32 s54, 4
    s_cbranch_scc1 p3x_105
    s_and_b32 s56, s53, 3
    s_lshr_b32 s57, s53, 2
    s_and_b32 s74, s57, 1
    s_lshl_b32 s75, s56, 2
    s_lshl_b32 s60, s58, 1
    s_add_u32 s75, s75, s60
    s_add_u32 s76, s75, 1
    s_sub_u32 s76, s76, s59
    s_add_u32 s75, s75, s59
    v_and_b32 v3, 15, v2
    v_mul_u32_u24 v3, 1280, v3
    v_lshrrev_b32 v4, 4, v2
    v_lshlrev_b32 v4, 3, v4
    v_add_u32 v5, v3, v4
    s_lshl_b32 s64, s52, 8
    s_lshl_b32 s60, s75, 4
    s_add_u32 s64, s64, s60
    s_mov_b32 s77, s64
    s_mul_i32 s64, s64, 1280
    s_add_u32 s65, s74, 0
    s_mul_i32 s61, s57, 5
    s_add_u32 s65, s65, s61
    s_lshl_b32 s65, s65, 5
    s_add_u32 s65, s65, s64
    buffer_load_dwordx2 v[200:201], v5, s[28:31], s65 offen
    s_add_u32 s65, s74, 1
    s_mul_i32 s61, s57, 5
    s_add_u32 s65, s65, s61
    s_lshl_b32 s65, s65, 5
    s_add_u32 s65, s65, s64
    buffer_load_dwordx2 v[202:203], v5, s[28:31], s65 offen
    s_add_u32 s65, s74, 2
    s_mul_i32 s61, s57, 5
    s_add_u32 s65, s65, s61
    s_lshl_b32 s65, s65, 5
    s_add_u32 s65, s65, s64
    buffer_load_dwordx2 v[204:205], v5, s[28:31], s65 offen
    s_add_u32 s65, s74, 3
    s_mul_i32 s61, s57, 5
    s_add_u32 s65, s65, s61
    s_lshl_b32 s65, s65, 5
    s_add_u32 s65, s65, s64
    buffer_load_dwordx2 v[206:207], v5, s[28:31], s65 offen
    s_add_u32 s65, s74, 4
    s_cmp_eq_u32 s65, 5
    s_cselect_b32 s65, 0, s65
    s_mul_i32 s61, s57, 5
    s_add_u32 s65, s65, s61
    s_lshl_b32 s65, s65, 5
    s_add_u32 s65, s65, s64
    buffer_load_dwordx2 v[208:209], v5, s[28:31], s65 offen
    v_lshlrev_b32 v6, 4, v2
    v_lshrrev_b32 v3, 5, v2
    v_mul_u32_u24 v3, 10240, v3
    v_bfe_u32 v4, v2, 4, 1
    v_lshlrev_b32 v4, 8, v4
    v_add_u32 v3, v3, v4
    v_and_b32 v4, 15, v2
    v_lshlrev_b32 v4, 4, v4
    v_add_u32 v10, v3, v4
    s_mul_i32 s64, s52, 0x100000
    s_add_u32 s64, s64, 0x100000
    s_mul_i32 s60, s59, 204800
    s_lshl_b32 s65, s75, 9
    s_add_u32 s65, s65, s64
    s_add_u32 s65, s65, s60
    s_lshl_b32 s66, s76, 9
    s_add_u32 s66, s66, s64
    s_add_u32 s66, s66, s60
    v_add_u32 v9, 8, v10
    v_lshrrev_b32 v3, 4, v2
    v_mul_u32_u24 v3, 20480, v3
    v_and_b32 v4, 15, v2
    v_lshlrev_b32 v4, 3, v4
    v_add_u32 v3, v3, v4
    v_add_u32 v4, 10240, v3
    s_cmp_eq_u32 s59, 0
    s_cselect_b64 vcc, -1, 0
    v_cndmask_b32 v8, v3, v10, vcc
    v_cndmask_b32 v9, v4, v9, vcc
    s_add_u32 s68, s65, 122880
    s_add_u32 s69, s66, 122880
    s_lshl_b32 s60, s75, 7
    s_add_u32 s60, s60, s64
    s_add_u32 s60, s60, 8192
    s_lshl_b32 s61, s76, 7
    s_add_u32 s61, s61, s64
    s_add_u32 s61, s61, 8192
    s_cmp_eq_u32 s59, 0
    s_cselect_b32 s68, s68, s60
    s_cselect_b32 s69, s69, s61
    s_mov_b32 s70, 81920
    s_cselect_b32 s70, 20480, s70
    v_mov_b32 v16, 0
    v_mov_b32 v17, 0
    v_mov_b32 v18, 0
    v_mov_b32 v19, 0
    v_mov_b32 v20, 0
    v_mov_b32 v21, 0
    v_mov_b32 v22, 0
    v_mov_b32 v23, 0
    v_mov_b32 v24, 0
    v_mov_b32 v25, 0
    v_mov_b32 v26, 0
    v_mov_b32 v27, 0
    v_mov_b32 v28, 0
    v_mov_b32 v29, 0
    v_mov_b32 v30, 0
    v_mov_b32 v31, 0
    v_mov_b32 v32, 0
    v_mov_b32 v33, 0
    v_mov_b32 v34, 0
    v_mov_b32 v35, 0
    v_mov_b32 v36, 0
    v_mov_b32 v37, 0
    v_mov_b32 v38, 0
    v_mov_b32 v39, 0
    v_mov_b32 v40, 0
    v_mov_b32 v41, 0
    v_mov_b32 v42, 0
    v_mov_b32 v43, 0
    v_mov_b32 v44, 0
    v_mov_b32 v45, 0
    v_mov_b32 v46, 0
    v_mov_b32 v47, 0
    v_mov_b32 v48, 0
    v_mov_b32 v49, 0
    v_mov_b32 v50, 0
    v_mov_b32 v51, 0
    v_mov_b32 v52, 0
    v_mov_b32 v53, 0
    v_mov_b32 v54, 0
    v_mov_b32 v55, 0
    s_mul_i32 s60, s59, 51200
    v_add_u32 v7, s60, v6
    ds_read_b128 v[160:163], v7 offset:0
    ds_read_b128 v[164:167], v7 offset:1024
    ds_read_b128 v[168:171], v7 offset:2048
    ds_read_b128 v[172:175], v7 offset:3072
    ds_read_b128 v[176:179], v7 offset:4096
    s_branch L_p3_a
p3x_105:
    s_cmp_lg_u32 s54, 6
    s_cbranch_scc1 L_p3_a
    v_mov_b32 v242, 3
    s_mov_b64 exec, 1
    s_cmp_lg_u32 s55, 0
    s_cbranch_scc1 fmix_106
    buffer_store_dword v242, v241, s[36:39], s27 offen
fdone_107:
    s_mov_b64 exec, -1
    s_mov_b32 s92, 0
poll_108:
    buffer_load_dword v243, v240, s[36:39], s3 offen sc1
pollc_110:
    s_waitcnt vmcnt(0)
    v_cmp_gt_u32 vcc, 3, v243
    s_cbranch_vccz polld_109
    s_add_u32 s92, s92, 1
    s_cmp_lt_u32 s92, 0x40000
    s_cbranch_scc1 poll_108
polld_109:
    s_cmp_eq_u32 s55, 0
    s_cbranch_scc1 acq_111
    buffer_inv sc1
    s_waitcnt vmcnt(0)
acq_111:
L_p3_a:
    s_barrier
    s_cmp_ge_u32 s54, 4
    s_cbranch_scc1 L_p3_np
    buffer_load_dwordx4 v[80:83], v10, s[36:39], s65 offen sc1
    s_add_u32 s65, s65, 20480
    buffer_load_dwordx4 v[84:87], v10, s[36:39], s66 offen sc1
    s_add_u32 s66, s66, 20480
    buffer_load_dwordx4 v[88:91], v10, s[36:39], s65 offen sc1
    s_add_u32 s65, s65, 20480
    buffer_load_dwordx4 v[92:95], v10, s[36:39], s66 offen sc1
    s_add_u32 s66, s66, 20480
    buffer_load_dwordx4 v[96:99], v10, s[36:39], s65 offen sc1
    s_add_u32 s65, s65, 20480
    buffer_load_dwordx4 v[100:103], v10, s[36:39], s66 offen sc1
    s_add_u32 s66, s66, 20480
    buffer_load_dwordx4 v[104:107], v10, s[36:39], s65 offen sc1
    s_add_u32 s65, s65, 20480
    buffer_load_dwordx4 v[108:111], v10, s[36:39], s66 offen sc1
    s_add_u32 s66, s66, 20480
    s_waitcnt vmcnt(6) lgkmcnt(0)
    v_mfma_f32_16x16x32_bf16 v[16:19], v[160:163], v[80:83], v[16:19]
    ds_read_b128 v[180:183], v7 offset:5120
    v_mfma_f32_16x16x32_bf16 v[20:23], v[160:163], v[84:87], v[20:23]
    v_mfma_f32_16x16x32_bf16 v[24:27], v[164:167], v[80:83], v[24:27]
    ds_read_b128 v[184:187], v7 offset:6144
    v_mfma_f32_16x16x32_bf16 v[28:31], v[164:167], v[84:87], v[28:31]
    buffer_load_dwordx4 v[112:115], v10, s[36:39], s65 offen sc1
    s_add_u32 s65, s65, 20480
    buffer_load_dwordx4 v[116:119], v10, s[36:39], s66 offen sc1
    s_add_u32 s66, s66, 20480
    v_mfma_f32_16x16x32_bf16 v[32:35], v[168:171], v[80:83], v[32:35]
    ds_read_b128 v[188:191], v7 offset:7168
    v_mfma_f32_16x16x32_bf16 v[36:39], v[168:171], v[84:87], v[36:39]
    v_mfma_f32_16x16x32_bf16 v[40:43], v[172:175], v[80:83], v[40:43]
    ds_read_b128 v[192:195], v7 offset:8192
    v_mfma_f32_16x16x32_bf16 v[44:47], v[172:175], v[84:87], v[44:47]
    v_mfma_f32_16x16x32_bf16 v[48:51], v[176:179], v[80:83], v[48:51]
    ds_read_b128 v[196:199], v7 offset:9216
    v_mfma_f32_16x16x32_bf16 v[52:55], v[176:179], v[84:87], v[52:55]
    s_waitcnt vmcnt(6) lgkmcnt(0)
    v_mfma_f32_16x16x32_bf16 v[16:19], v[180:183], v[88:91], v[16:19]
    ds_read_b128 v[160:163], v7 offset:10240
    v_mfma_f32_16x16x32_bf16 v[20:23], v[180:183], v[92:95], v[20:23]
    v_mfma_f32_16x16x32_bf16 v[24:27], v[184:187], v[88:91], v[24:27]
    ds_read_b128 v[164:167], v7 offset:11264
    v_mfma_f32_16x16x32_bf16 v[28:31], v[184:187], v[92:95], v[28:31]
    buffer_load_dwordx4 v[120:123], v10, s[36:39], s65 offen sc1
    s_add_u32 s65, s65, 20480
    buffer_load_dwordx4 v[124:127], v10, s[36:39], s66 offen sc1
    s_add_u32 s66, s66, 20480
    v_mfma_f32_16x16x32_bf16 v[32:35], v[188:191], v[88:91], v[32:35]
    ds_read_b128 v[168:171], v7 offset:12288
    v_mfma_f32_16x16x32_bf16 v[36:39], v[188:191], v[92:95], v[36:39]
    v_mfma_f32_16x16x32_bf16 v[40:43], v[192:195], v[88:91], v[40:43]
    ds_read_b128 v[172:175], v7 offset:13312
    v_mfma_f32_16x16x32_bf16 v[44:47], v[192:195], v[92:95], v[44:47]
    v_mfma_f32_16x16x32_bf16 v[48:51], v[196:199], v[88:91], v[48:51]
    ds_read_b128 v[176:179], v7 offset:14336
    v_mfma_f32_16x16x32_bf16 v[52:55], v[196:199], v[92:95], v[52:55]
    s_waitcnt vmcnt(6) lgkmcnt(0)
    v_mfma_f32_16x16x32_bf16 v[16:19], v[160:163], v[96:99], v[16:19]
    ds_read_b128 v[180:183], v7 offset:15360
    v_mfma_f32_16x16x32_bf16 v[20:23], v[160:163], v[100:103], v[20:23]
    v_mfma_f32_16x16x32_bf16 v[24:27], v[164:167], v[96:99], v[24:27]
    ds_read_b128 v[184:187], v7 offset:16384
    v_mfma_f32_16x16x32_bf16 v[28:31], v[164:167], v[100:103], v[28:31]
    buffer_load_dwordx2 v[128:129], v8, s[36:39], s68 offen sc1
    buffer_load_dwordx2 v[130:131], v9, s[36:39], s68 offen sc1
    s_add_u32 s68, s68, s70
    buffer_load_dwordx2 v[132:133], v8, s[36:39], s69 offen sc1
    buffer_load_dwordx2 v[134:135], v9, s[36:39], s69 offen sc1
    s_add_u32 s69, s69, s70
    v_mfma_f32_16x16x32_bf16 v[32:35], v[168:171], v[96:99], v[32:35]
    ds_read_b128 v[188:191], v7 offset:17408
    v_mfma_f32_16x16x32_bf16 v[36:39], v[168:171], v[100:103], v[36:39]
    v_mfma_f32_16x16x32_bf16 v[40:43], v[172:175], v[96:99], v[40:43]
    ds_read_b128 v[192:195], v7 offset:18432
    v_mfma_f32_16x16x32_bf16 v[44:47], v[172:175], v[100:103], v[44:47]
    v_mfma_f32_16x16x32_bf16 v[48:51], v[176:179], v[96:99], v[48:51]
    ds_read_b128 v[196:199], v7 offset:19456
    v_mfma_f32_16x16x32_bf16 v[52:55], v[176:179], v[100:103], v[52:55]
    s_waitcnt vmcnt(8) lgkmcnt(0)
    v_mfma_f32_16x16x32_bf16 v[16:19], v[180:183], v[104:107], v[16:19]
    ds_read_b128 v[160:163], v7 offset:20480
    v_mfma_f32_16x16x32_bf16 v[20:23], v[180:183], v[108:111], v[20:23]
    v_mfma_f32_16x16x32_bf16 v[24:27], v[184:187], v[104:107], v[24:27]
    ds_read_b128 v[164:167], v7 offset:21504
    v_mfma_f32_16x16x32_bf16 v[28:31], v[184:187], v[108:111], v[28:31]
    buffer_load_dwordx2 v[136:137], v8, s[36:39], s68 offen sc1
    buffer_load_dwordx2 v[138:139], v9, s[36:39], s68 offen sc1
    s_add_u32 s68, s68, s70
    buffer_load_dwordx2 v[140:141], v8, s[36:39], s69 offen sc1
    buffer_load_dwordx2 v[142:143], v9, s[36:39], s69 offen sc1
    s_add_u32 s69, s69, s70
    v_mfma_f32_16x16x32_bf16 v[32:35], v[188:191], v[104:107], v[32:35]
    ds_read_b128 v[168:171], v7 offset:22528
    v_mfma_f32_16x16x32_bf16 v[36:39], v[188:191], v[108:111], v[36:39]
    v_mfma_f32_16x16x32_bf16 v[40:43], v[192:195], v[104:107], v[40:43]
    ds_read_b128 v[172:175], v7 offset:23552
    v_mfma_f32_16x16x32_bf16 v[44:47], v[192:195], v[108:111], v[44:47]
    v_mfma_f32_16x16x32_bf16 v[48:51], v[196:199], v[104:107], v[48:51]
    ds_read_b128 v[176:179], v7 offset:24576
    v_mfma_f32_16x16x32_bf16 v[52:55], v[196:199], v[108:111], v[52:55]
    s_waitcnt vmcnt(10) lgkmcnt(0)
    v_mfma_f32_16x16x32_bf16 v[16:19], v[160:163], v[112:115], v[16:19]
    ds_read_b128 v[180:183], v7 offset:25600
    v_mfma_f32_16x16x32_bf16 v[20:23], v[160:163], v[116:119], v[20:23]
    v_mfma_f32_16x16x32_bf16 v[24:27], v[164:167], v[112:115], v[24:27]
    ds_read_b128 v[184:187], v7 offset:26624
    v_mfma_f32_16x16x32_bf16 v[28:31], v[164:167], v[116:119], v[28:31]
    buffer_load_dwordx2 v[144:145], v8, s[36:39], s68 offen sc1
    buffer_load_dwordx2 v[146:147], v9, s[36:39], s68 offen sc1
    s_add_u32 s68, s68, s70
    buffer_load_dwordx2 v[148:149], v8, s[36:39], s69 offen sc1
    buffer_load_dwordx2 v[150:151], v9, s[36:39], s69 offen sc1
    s_add_u32 s69, s69, s70
    v_mfma_f32_16x16x32_bf16 v[32:35], v[168:171], v[112:115], v[32:35]
    ds_read_b128 v[188:191], v7 offset:27648
    v_mfma_f32_16x16x32_bf16 v[36:39], v[168:171], v[116:119], v[36:39]
    v_mfma_f32_16x16x32_bf16 v[40:43], v[172:175], v[112:115], v[40:43]
    ds_read_b128 v[192:195], v7 offset:28672
    v_mfma_f32_16x16x32_bf16 v[44:47], v[172:175], v[116:119], v[44:47]
    v_mfma_f32_16x16x32_bf16 v[48:51], v[176:179], v[112:115], v[48:51]
    ds_read_b128 v[196:199], v7 offset:29696
    v_mfma_f32_16x16x32_bf16 v[52:55], v[176:179], v[116:119], v[52:55]
    s_waitcnt vmcnt(12) lgkmcnt(0)
    v_mfma_f32_16x16x32_bf16 v[16:19], v[180:183], v[120:123], v[16:19]
    ds_read_b128 v[160:163], v7 offset:30720
    v_mfma_f32_16x16x32_bf16 v[20:23], v[180:183], v[124:127], v[20:23]
    v_mfma_f32_16x16x32_bf16 v[24:27], v[184:187], v[120:123], v[24:27]
    ds_read_b128 v[164:167], v7 offset:31744
    v_mfma_f32_16x16x32_bf16 v[28:31], v[184:187], v[124:127], v[28:31]
    buffer_load_dwordx2 v[152:153], v8, s[36:39], s68 offen sc1
    buffer_load_dwordx2 v[154:155], v9, s[36:39], s68 offen sc1
    s_add_u32 s68, s68, s70
    buffer_load_dwordx2 v[156:157], v8, s[36:39], s69 offen sc1
    buffer_load_dwordx2 v[158:159], v9, s[36:39], s69 offen sc1
    s_add_u32 s69, s69, s70
    v_mfma_f32_16x16x32_bf16 v[32:35], v[188:191], v[120:123], v[32:35]
    ds_read_b128 v[168:171], v7 offset:32768
    v_mfma_f32_16x16x32_bf16 v[36:39], v[188:191], v[124:127], v[36:39]
    v_mfma_f32_16x16x32_bf16 v[40:43], v[192:195], v[120:123], v[40:43]
    ds_read_b128 v[172:175], v7 offset:33792
    v_mfma_f32_16x16x32_bf16 v[44:47], v[192:195], v[124:127], v[44:47]
    v_mfma_f32_16x16x32_bf16 v[48:51], v[196:199], v[120:123], v[48:51]
    ds_read_b128 v[176:179], v7 offset:34816
    v_mfma_f32_16x16x32_bf16 v[52:55], v[196:199], v[124:127], v[52:55]
    s_waitcnt vmcnt(12) lgkmcnt(0)
    v_mfma_f32_16x16x32_bf16 v[16:19], v[160:163], v[128:131], v[16:19]
    ds_read_b128 v[180:183], v7 offset:35840
    v_mfma_f32_16x16x32_bf16 v[20:23], v[160:163], v[132:135], v[20:23]
    v_mfma_f32_16x16x32_bf16 v[24:27], v[164:167], v[128:131], v[24:27]
    ds_read_b128 v[184:187], v7 offset:36864
    v_mfma_f32_16x16x32_bf16 v[28:31], v[164:167], v[132:135], v[28:31]
    v_mfma_f32_16x16x32_bf16 v[32:35], v[168:171], v[128:131], v[32:35]
    ds_read_b128 v[188:191], v7 offset:37888
    v_mfma_f32_16x16x32_bf16 v[36:39], v[168:171], v[132:135], v[36:39]
    v_mfma_f32_16x16x32_bf16 v[40:43], v[172:175], v[128:131], v[40:43]
    ds_read_b128 v[192:195], v7 offset:38912
    v_mfma_f32_16x16x32_bf16 v[44:47], v[172:175], v[132:135], v[44:47]
    v_mfma_f32_16x16x32_bf16 v[48:51], v[176:179], v[128:131], v[48:51]
    ds_read_b128 v[196:199], v7 offset:39936
    v_mfma_f32_16x16x32_bf16 v[52:55], v[176:179], v[132:135], v[52:55]
    s_waitcnt vmcnt(8) lgkmcnt(0)
    v_mfma_f32_16x16x32_bf16 v[16:19], v[180:183], v[136:139], v[16:19]
    ds_read_b128 v[160:163], v7 offset:40960
    v_mfma_f32_16x16x32_bf16 v[20:23], v[180:183], v[140:143], v[20:23]
    v_mfma_f32_16x16x32_bf16 v[24:27], v[184:187], v[136:139], v[24:27]
    ds_read_b128 v[164:167], v7 offset:41984
    v_mfma_f32_16x16x32_bf16 v[28:31], v[184:187], v[140:143], v[28:31]
    v_mfma_f32_16x16x32_bf16 v[32:35], v[188:191], v[136:139], v[32:35]
    ds_read_b128 v[168:171], v7 offset:43008
    v_mfma_f32_16x16x32_bf16 v[36:39], v[188:191], v[140:143], v[36:39]
    v_mfma_f32_16x16x32_bf16 v[40:43], v[192:195], v[136:139], v[40:43]
    ds_read_b128 v[172:175], v7 offset:44032
    v_mfma_f32_16x16x32_bf16 v[44:47], v[192:195], v[140:143], v[44:47]
    v_mfma_f32_16x16x32_bf16 v[48:51], v[196:199], v[136:139], v[48:51]
    ds_read_b128 v[176:179], v7 offset:45056
    v_mfma_f32_16x16x32_bf16 v[52:55], v[196:199], v[140:143], v[52:55]
    s_waitcnt vmcnt(4) lgkmcnt(0)
    v_mfma_f32_16x16x32_bf16 v[16:19], v[160:163], v[144:147], v[16:19]
    ds_read_b128 v[180:183], v7 offset:46080
    v_mfma_f32_16x16x32_bf16 v[20:23], v[160:163], v[148:151], v[20:23]
    v_mfma_f32_16x16x32_bf16 v[24:27], v[164:167], v[144:147], v[24:27]
    ds_read_b128 v[184:187], v7 offset:47104
    v_mfma_f32_16x16x32_bf16 v[28:31], v[164:167], v[148:151], v[28:31]
    v_mfma_f32_16x16x32_bf16 v[32:35], v[168:171], v[144:147], v[32:35]
    ds_read_b128 v[188:191], v7 offset:48128
    v_mfma_f32_16x16x32_bf16 v[36:39], v[168:171], v[148:151], v[36:39]
    v_mfma_f32_16x16x32_bf16 v[40:43], v[172:175], v[144:147], v[40:43]
    ds_read_b128 v[192:195], v7 offset:49152
    v_mfma_f32_16x16x32_bf16 v[44:47], v[172:175], v[148:151], v[44:47]
    v_mfma_f32_16x16x32_bf16 v[48:51], v[176:179], v[144:147], v[48:51]
    ds_read_b128 v[196:199], v7 offset:50176
    v_mfma_f32_16x16x32_bf16 v[52:55], v[176:179], v[148:151], v[52:55]
    s_waitcnt vmcnt(0) lgkmcnt(0)
    v_mfma_f32_16x16x32_bf16 v[16:19], v[180:183], v[152:155], v[16:19]
    v_mfma_f32_16x16x32_bf16 v[20:23], v[180:183], v[156:159], v[20:23]
    v_mfma_f32_16x16x32_bf16 v[24:27], v[184:187], v[152:155], v[24:27]
    v_mfma_f32_16x16x32_bf16 v[28:31], v[184:187], v[156:159], v[28:31]
    v_mfma_f32_16x16x32_bf16 v[32:35], v[188:191], v[152:155], v[32:35]
    v_mfma_f32_16x16x32_bf16 v[36:39], v[188:191], v[156:159], v[36:39]
    v_mfma_f32_16x16x32_bf16 v[40:43], v[192:195], v[152:155], v[40:43]
    v_mfma_f32_16x16x32_bf16 v[44:47], v[192:195], v[156:159], v[44:47]
    v_mfma_f32_16x16x32_bf16 v[48:51], v[196:199], v[152:155], v[48:51]
    v_mfma_f32_16x16x32_bf16 v[52:55], v[196:199], v[156:159], v[52:55]
    s_nop 7
    v_lshlrev_b32 v3, 4, v2
    s_mul_i32 s60, s54, 5120
    s_add_u32 s60, s60, 102400
    v_add_u32 v4, s60, v3
    ds_write_b128 v4, v[20:23] offset:0
    ds_write_b128 v4, v[28:31] offset:1024
    ds_write_b128 v4, v[36:39] offset:2048
    ds_write_b128 v4, v[44:47] offset:3072
    ds_write_b128 v4, v[52:55] offset:4096
    s_waitcnt lgkmcnt(0)
    s_barrier
    s_xor_b32 s60, s54, 2
    s_mul_i32 s60, s60, 5120
    s_add_u32 s60, s60, 102400
    v_add_u32 v4, s60, v3
    ds_read_b128 v[20:23], v4 offset:0
    ds_read_b128 v[28:31], v4 offset:1024
    ds_read_b128 v[36:39], v4 offset:2048
    ds_read_b128 v[44:47], v4 offset:3072
    ds_read_b128 v[52:55], v4 offset:4096
    s_waitcnt lgkmcnt(0)
    v_add_f32 v16, v16, v20
    v_add_f32 v17, v17, v21
    v_add_f32 v18, v18, v22
    v_add_f32 v19, v19, v23
    v_add_f32 v24, v24, v28
    v_add_f32 v25, v25, v29
    v_add_f32 v26, v26, v30
    v_add_f32 v27, v27, v31
    v_add_f32 v32, v32, v36
    v_add_f32 v33, v33, v37
    v_add_f32 v34, v34, v38
    v_add_f32 v35, v35, v39
    v_add_f32 v40, v40, v44
    v_add_f32 v41, v41, v45
    v_add_f32 v42, v42, v46
    v_add_f32 v43, v43, v47
    v_add_f32 v48, v48, v52
    v_add_f32 v49, v49, v53
    v_add_f32 v50, v50, v54
    v_add_f32 v51, v51, v55
    v_lshlrev_b32 v8, 16, v200
    v_add_f32 v16, v16, v8
    v_and_b32 v8, 0xffff0000, v200
    v_add_f32 v17, v17, v8
    v_lshlrev_b32 v8, 16, v201
    v_add_f32 v18, v18, v8
    v_and_b32 v8, 0xffff0000, v201
    v_add_f32 v19, v19, v8
    v_cvt_pk_bf16_f32 v246, v16, v17
    v_cvt_pk_bf16_f32 v247, v18, v19
    v_lshlrev_b32 v8, 16, v202
    v_add_f32 v24, v24, v8
    v_and_b32 v8, 0xffff0000, v202
    v_add_f32 v25, v25, v8
    v_lshlrev_b32 v8, 16, v203
    v_add_f32 v26, v26, v8
    v_and_b32 v8, 0xffff0000, v203
    v_add_f32 v27, v27, v8
    v_cvt_pk_bf16_f32 v248, v24, v25
    v_cvt_pk_bf16_f32 v249, v26, v27
    v_lshlrev_b32 v8, 16, v204
    v_add_f32 v32, v32, v8
    v_and_b32 v8, 0xffff0000, v204
    v_add_f32 v33, v33, v8
    v_lshlrev_b32 v8, 16, v205
    v_add_f32 v34, v34, v8
    v_and_b32 v8, 0xffff0000, v205
    v_add_f32 v35, v35, v8
    v_cvt_pk_bf16_f32 v250, v32, v33
    v_cvt_pk_bf16_f32 v251, v34, v35
    v_lshlrev_b32 v8, 16, v206
    v_add_f32 v40, v40, v8
    v_and_b32 v8, 0xffff0000, v206
    v_add_f32 v41, v41, v8
    v_lshlrev_b32 v8, 16, v207
    v_add_f32 v42, v42, v8
    v_and_b32 v8, 0xffff0000, v207
    v_add_f32 v43, v43, v8
    v_cvt_pk_bf16_f32 v252, v40, v41
    v_cvt_pk_bf16_f32 v253, v42, v43
    v_lshlrev_b32 v8, 16, v208
    v_add_f32 v48, v48, v8
    v_and_b32 v8, 0xffff0000, v208
    v_add_f32 v49, v49, v8
    v_lshlrev_b32 v8, 16, v209
    v_add_f32 v50, v50, v8
    v_and_b32 v8, 0xffff0000, v209
    v_add_f32 v51, v51, v8
    v_cvt_pk_bf16_f32 v254, v48, v49
    v_cvt_pk_bf16_f32 v255, v50, v51
    s_mul_i32 s64, s52, 0x50000
    s_add_u32 s64, s64, 0x1400000
    s_mul_i32 s60, s75, 20480
    s_add_u32 s64, s64, s60
    v_lshrrev_b32 v3, 5, v2
    v_lshlrev_b32 v3, 8, v3
    v_and_b32 v4, 15, v2
    v_lshlrev_b32 v4, 4, v4
    v_add_u32 v3, v3, v4
    v_bfe_u32 v4, v2, 4, 1
    v_lshlrev_b32 v4, 3, v4
    v_add_u32 v3, v3, v4
    s_add_u32 s65, s74, 0
    s_mul_i32 s61, s57, 5
    s_add_u32 s65, s65, s61
    s_lshl_b32 s65, s65, 9
    s_add_u32 s65, s65, s64
    buffer_store_dwordx2 v[246:247], v3, s[36:39], s65 offen
    s_add_u32 s65, s74, 1
    s_mul_i32 s61, s57, 5
    s_add_u32 s65, s65, s61
    s_lshl_b32 s65, s65, 9
    s_add_u32 s65, s65, s64
    buffer_store_dwordx2 v[248:249], v3, s[36:39], s65 offen
    s_add_u32 s65, s74, 2
    s_mul_i32 s61, s57, 5
    s_add_u32 s65, s65, s61
    s_lshl_b32 s65, s65, 9
    s_add_u32 s65, s65, s64
    buffer_store_dwordx2 v[250:251], v3, s[36:39], s65 offen
    s_add_u32 s65, s74, 3
    s_mul_i32 s61, s57, 5
    s_add_u32 s65, s65, s61
    s_lshl_b32 s65, s65, 9
    s_add_u32 s65, s65, s64
    buffer_store_dwordx2 v[252:253], v3, s[36:39], s65 offen
    s_add_u32 s65, s74, 4
    s_cmp_eq_u32 s65, 5
    s_cselect_b32 s65, 0, s65
    s_mul_i32 s61, s57, 5
    s_add_u32 s65, s65, s61
    s_lshl_b32 s65, s65, 9
    s_add_u32 s65, s65, s64
    buffer_store_dwordx2 v[254:255], v3, s[36:39], s65 offen
    v_mov_b32 v9, 0x3f803f80
    v_mov_b32 v10, 0
    v_mov_b32 v11, 0
    v_mov_b32 v12, 0
    v_mov_b32 v13, 0
    v_dot2_f32_bf16 v10, v246, v9, v10
    v_dot2_f32_bf16 v11, v246, v246, v11
    v_dot2_f32_bf16 v12, v247, v9, v12
    v_dot2_f32_bf16 v13, v247, v247, v13
    v_dot2_f32_bf16 v10, v248, v9, v10
    v_dot2_f32_bf16 v11, v248, v248, v11
    v_dot2_f32_bf16 v12, v249, v9, v12
    v_dot2_f32_bf16 v13, v249, v249, v13
    v_dot2_f32_bf16 v10, v250, v9, v10
    v_dot2_f32_bf16 v11, v250, v250, v11
    v_dot2_f32_bf16 v12, v251, v9, v12
    v_dot2_f32_bf16 v13, v251, v251, v13
    v_dot2_f32_bf16 v10, v252, v9, v10
    v_dot2_f32_bf16 v11, v252, v252, v11
    v_dot2_f32_bf16 v12, v253, v9, v12
    v_dot2_f32_bf16 v13, v253, v253, v13
    v_dot2_f32_bf16 v10, v254, v9, v10
    v_dot2_f32_bf16 v11, v254, v254, v11
    v_dot2_f32_bf16 v12, v255, v9, v12
    v_dot2_f32_bf16 v13, v255, v255, v13
    s_nop 1
    v_add_f32 v10, v10, v12
    v_add_f32 v11, v11, v13
    v_mov_b32 v12, v10
    v_mov_b32 v13, v11
    s_nop 0
    v_permlane32_swap_b32 v10, v12
    v_permlane32_swap_b32 v11, v13
    v_add_f32 v10, v10, v12
    v_add_f32 v11, v11, v13
    v_mov_b32 v12, v10
    v_mov_b32 v13, v11
    s_nop 0
    v_permlane16_swap_b32 v10, v12
    v_permlane16_swap_b32 v11, v13
    v_add_f32 v10, v10, v12
    v_add_f32 v11, v11, v13
    v_and_b32 v3, 15, v2
    v_lshlrev_b32 v3, 3, v3
    s_lshl_b32 s60, s52, 14
    s_lshl_b32 s61, s57, 11
    s_add_u32 s60, s60, s61
    s_lshl_b32 s61, s75, 7
    s_add_u32 s60, s60, s61
    s_add_u32 s60, s60, 0x20000
    s_mov_b64 s[62:63], exec
    s_mov_b64 exec, 0xffff
    buffer_store_dwordx2 v[10:11], v3, s[36:39], s60 offen
    s_mov_b64 exec, s[62:63]
    s_waitcnt vmcnt(0)
    s_branch L_p3_d
L_p3_np:
    s_barrier
    s_cmp_lg_u32 s54, 7
    s_cbranch_scc1 p3g_112
    s_cmp_ge_u32 s53, 28
    s_cbranch_scc1 p3g_112
    s_and_b32 s56, s53, 1
    s_lshr_b32 s57, s53, 1
    v_lshrrev_b32 v22, 5, v2
    v_mul_u32_u24 v22, 55296, v22
    v_and_b32 v23, 31, v2
    v_lshlrev_b32 v23, 7, v23
    v_add_u32 v22, v22, v23
    s_mul_i32 s60, s52, 0x100000
    s_add_u32 s60, s60, 0x100000
    s_mul_i32 s61, s56, 442368
    s_add_u32 s60, s60, s61
    s_lshl_b32 s61, s57, 12
    s_add_u32 s60, s60, s61
    s_cmp_eq_u32 s57, 13
    s_mov_b32 s61, -1
    s_cselect_b32 s61, 0xffff, s61
    s_mov_b32 exec_lo, s61
    s_mov_b32 exec_hi, s61
    buffer_load_dword v20, v22, s[36:39], s60 offen sc1
    s_add_u32 s60, s60, 110592
    buffer_load_dword v20, v22, s[36:39], s60 offen sc1
    s_add_u32 s60, s60, 110592
    buffer_load_dword v20, v22, s[36:39], s60 offen sc1
    s_add_u32 s60, s60, 110592
    buffer_load_dword v20, v22, s[36:39], s60 offen sc1
pge_113:
    s_mov_b64 exec, -1
p3g_112:
    s_cmp_ge_u32 s54, 6
    s_cbranch_scc1 L_p3_d
    s_cmp_ge_u32 s53, 28
    s_cbranch_scc1 L_p3_d
    s_and_b32 s56, s53, 1
    s_lshr_b32 s57, s53, 1
    s_mov_b32 s32, s12
    s_mov_b32 s33, s13
    s_mov_b32 s34, 0x21c000
    s_mov_b32 s35, 0x00020000
    s_sub_u32 s63, s54, 4
    v_lshlrev_b32 v16, 4, v2
    v_lshrrev_b32 v3, 4, v2
    s_lshl_b32 s60, s63, 2
    v_or_b32 v4, s60, v3
    v_lshlrev_b32 v4, 1, v4
    v_and_b32 v5, 15, v2
    v_xor_b32 v4, v4, v5
    v_lshlrev_b32 v4, 4, v4
    s_lshl_b32 s60, s63, 3
    v_add_u32 v3, s60, v3
    v_mul_u32_u24 v3, 3456, v3
    v_add_u32 v17, v3, v4
    s_mul_i32 s64, s52, 0x50000
    s_add_u32 s64, s64, 0x1400000
    s_mul_i32 s60, s56, 163840
    s_add_u32 s64, s64, s60
    s_lshl_b32 s60, s63, 10
    s_add_u32 s64, s64, s60
    s_lshl_b32 s65, s57, 8
    s_lshl_b32 s66, s63, 13
    s_add_u32 s66, s66, 81920
    s_lshl_b32 s67, s63, 11
    s_mov_b32 s68, 0
    s_mov_b32 s70, 0
    s_add_u32 s60, s68, s67
    s_mov_b32 m0, s60
    s_add_u32 s61, s65, 0
    buffer_load_dwordx4 v17, s[32:35], s61 offen lds
    s_add_u32 s60, s68, s67
    s_add_u32 s60, s60, 1024
    s_mov_b32 m0, s60
    s_add_u32 s61, s65, 13824
    buffer_load_dwordx4 v17, s[32:35], s61 offen lds
    s_add_u32 s60, s68, s67
    s_add_u32 s60, s60, 4096
    s_mov_b32 m0, s60
    s_add_u32 s61, s65, 55296
    buffer_load_dwordx4 v17, s[32:35], s61 offen lds
    s_add_u32 s60, s68, s67
    s_add_u32 s60, s60, 5120
    s_mov_b32 m0, s60
    s_add_u32 s61, s65, 69120
    buffer_load_dwordx4 v17, s[32:35], s61 offen lds
    s_add_u32 s60, s68, s67
    s_add_u32 s60, s60, 8192
    s_mov_b32 m0, s60
    s_add_u32 s61, s65, 110592
    buffer_load_dwordx4 v17, s[32:35], s61 offen lds
    s_add_u32 s60, s68, s67
    s_add_u32 s60, s60, 9216
    s_mov_b32 m0, s60
    s_add_u32 s61, s65, 124416
    buffer_load_dwordx4 v17, s[32:35], s61 offen lds
    s_add_u32 s60, s68, s67
    s_add_u32 s60, s60, 12288
    s_mov_b32 m0, s60
    s_add_u32 s61, s65, 165888
    buffer_load_dwordx4 v17, s[32:35], s61 offen lds
    s_add_u32 s60, s68, s67
    s_add_u32 s60, s60, 13312
    s_mov_b32 m0, s60
    s_add_u32 s61, s65, 179712
    buffer_load_dwordx4 v17, s[32:35], s61 offen lds
    s_add_u32 s65, s65, 221184
    s_add_u32 s68, s68, 16384
    s_cmp_eq_u32 s68, 81920
    s_cselect_b32 s68, 0, s68
    s_add_u32 s60, s68, s67
    s_mov_b32 m0, s60
    s_add_u32 s61, s65, 0
    buffer_load_dwordx4 v17, s[32:35], s61 offen lds
    s_add_u32 s60, s68, s67
    s_add_u32 s60, s60, 1024
    s_mov_b32 m0, s60
    s_add_u32 s61, s65, 13824
    buffer_load_dwordx4 v17, s[32:35], s61 offen lds
    s_add_u32 s60, s68, s67
    s_add_u32 s60, s60, 4096
    s_mov_b32 m0, s60
    s_add_u32 s61, s65, 55296
    buffer_load_dwordx4 v17, s[32:35], s61 offen lds
    s_add_u32 s60, s68, s67
    s_add_u32 s60, s60, 5120
    s_mov_b32 m0, s60
    s_add_u32 s61, s65, 69120
    buffer_load_dwordx4 v17, s[32:35], s61 offen lds
    s_add_u32 s60, s68, s67
    s_add_u32 s60, s60, 8192
    s_mov_b32 m0, s60
    s_add_u32 s61, s65, 110592
    buffer_load_dwordx4 v17, s[32:35], s61 offen lds
    s_add_u32 s60, s68, s67
    s_add_u32 s60, s60, 9216
    s_mov_b32 m0, s60
    s_add_u32 s61, s65, 124416
    buffer_load_dwordx4 v17, s[32:35], s61 offen lds
    s_add_u32 s60, s68, s67
    s_add_u32 s60, s60, 12288
    s_mov_b32 m0, s60
    s_add_u32 s61, s65, 165888
    buffer_load_dwordx4 v17, s[32:35], s61 offen lds
    s_add_u32 s60, s68, s67
    s_add_u32 s60, s60, 13312
    s_mov_b32 m0, s60
    s_add_u32 s61, s65, 179712
    buffer_load_dwordx4 v17, s[32:35], s61 offen lds
    s_add_u32 s65, s65, 221184
    s_add_u32 s68, s68, 16384
    s_cmp_eq_u32 s68, 81920
    s_cselect_b32 s68, 0, s68
    s_add_u32 s60, s68, s67
    s_mov_b32 m0, s60
    s_add_u32 s61, s65, 0
    buffer_load_dwordx4 v17, s[32:35], s61 offen lds
    s_add_u32 s60, s68, s67
    s_add_u32 s60, s60, 1024
    s_mov_b32 m0, s60
    s_add_u32 s61, s65, 13824
    buffer_load_dwordx4 v17, s[32:35], s61 offen lds
    s_add_u32 s60, s68, s67
    s_add_u32 s60, s60, 4096
    s_mov_b32 m0, s60
    s_add_u32 s61, s65, 55296
    buffer_load_dwordx4 v17, s[32:35], s61 offen lds
    s_add_u32 s60, s68, s67
    s_add_u32 s60, s60, 5120
    s_mov_b32 m0, s60
    s_add_u32 s61, s65, 69120
    buffer_load_dwordx4 v17, s[32:35], s61 offen lds
    s_add_u32 s60, s68, s67
    s_add_u32 s60, s60, 8192
    s_mov_b32 m0, s60
    s_add_u32 s61, s65, 110592
    buffer_load_dwordx4 v17, s[32:35], s61 offen lds
    s_add_u32 s60, s68, s67
    s_add_u32 s60, s60, 9216
    s_mov_b32 m0, s60
    s_add_u32 s61, s65, 124416
    buffer_load_dwordx4 v17, s[32:35], s61 offen lds
    s_add_u32 s60, s68, s67
    s_add_u32 s60, s60, 12288
    s_mov_b32 m0, s60
    s_add_u32 s61, s65, 165888
    buffer_load_dwordx4 v17, s[32:35], s61 offen lds
    s_add_u32 s60, s68, s67
    s_add_u32 s60, s60, 13312
    s_mov_b32 m0, s60
    s_add_u32 s61, s65, 179712
    buffer_load_dwordx4 v17, s[32:35], s61 offen lds
    s_add_u32 s65, s65, 221184
    s_add_u32 s68, s68, 16384
    s_cmp_eq_u32 s68, 81920
    s_cselect_b32 s68, 0, s68
    s_add_u32 s60, s68, s67
    s_mov_b32 m0, s60
    s_add_u32 s61, s65, 0
    buffer_load_dwordx4 v17, s[32:35], s61 offen lds
    s_add_u32 s60, s68, s67
    s_add_u32 s60, s60, 1024
    s_mov_b32 m0, s60
    s_add_u32 s61, s65, 13824
    buffer_load_dwordx4 v17, s[32:35], s61 offen lds
    s_add_u32 s60, s68, s67
    s_add_u32 s60, s60, 4096
    s_mov_b32 m0, s60
    s_add_u32 s61, s65, 55296
    buffer_load_dwordx4 v17, s[32:35], s61 offen lds
    s_add_u32 s60, s68, s67
    s_add_u32 s60, s60, 5120
    s_mov_b32 m0, s60
    s_add_u32 s61, s65, 69120
    buffer_load_dwordx4 v17, s[32:35], s61 offen lds
    s_add_u32 s60, s68, s67
    s_add_u32 s60, s60, 8192
    s_mov_b32 m0, s60
    s_add_u32 s61, s65, 110592
    buffer_load_dwordx4 v17, s[32:35], s61 offen lds
    s_add_u32 s60, s68, s67
    s_add_u32 s60, s60, 9216
    s_mov_b32 m0, s60
    s_add_u32 s61, s65, 124416
    buffer_load_dwordx4 v17, s[32:35], s61 offen lds
    s_add_u32 s60, s68, s67
    s_add_u32 s60, s60, 12288
    s_mov_b32 m0, s60
    s_add_u32 s61, s65, 165888
    buffer_load_dwordx4 v17, s[32:35], s61 offen lds
    s_add_u32 s60, s68, s67
    s_add_u32 s60, s60, 13312
    s_mov_b32 m0, s60
    s_add_u32 s61, s65, 179712
    buffer_load_dwordx4 v17, s[32:35], s61 offen lds
    s_add_u32 s65, s65, 221184
    s_add_u32 s68, s68, 16384
    s_cmp_eq_u32 s68, 81920
    s_cselect_b32 s68, 0, s68
L_p3_d:
    s_barrier
    s_cmp_lg_u32 s54, 6
    s_cbranch_scc1 L_p4_a
    v_mov_b32 v242, 4
    s_mov_b64 exec, 1
    s_cmp_lg_u32 s55, 0
    s_cbranch_scc1 fmix_114
    buffer_store_dword v242, v241, s[36:39], s27 offen
fdone_115:
    s_mov_b64 exec, -1
    s_mov_b32 s92, 0
poll_116:
    buffer_load_dword v243, v240, s[36:39], s3 offen sc1
pollc_118:
    s_waitcnt vmcnt(0)
    v_cmp_gt_u32 vcc, 4, v243
    s_cbranch_vccz polld_117
    s_add_u32 s92, s92, 1
    s_cmp_lt_u32 s92, 0x40000
    s_cbranch_scc1 poll_116
polld_117:
    s_cmp_eq_u32 s55, 0
    s_cbranch_scc1 acq_119
    buffer_inv sc1
    s_waitcnt vmcnt(0)
acq_119:
L_p4_a:
    s_barrier
    s_and_b32 s56, s53, 1
    s_lshr_b32 s57, s53, 1
    s_cmp_ge_u32 s53, 28
    s_cbranch_scc1 L_p4_idle
    s_cmp_ge_u32 s54, 4
    s_cbranch_scc1 L_p4_np
    v_lshlrev_b32 v3, 4, v2
    s_lshl_b32 s60, s58, 12
    s_add_u32 s60, s60, 81920
    v_add_u32 v144, s60, v3
    v_and_b32 v3, 15, v2
    v_lshrrev_b32 v4, 4, v2
    v_lshrrev_b32 v5, 2, v3
    v_and_b32 v6, 3, v3
    v_lshlrev_b32 v7, 3, v4
    v_add_u32 v7, v7, v5
    v_and_b32 v8, 1, v4
    v_lshlrev_b32 v8, 2, v8
    v_or_b32 v8, v8, v5
    v_lshlrev_b32 v7, 8, v7
    v_lshlrev_b32 v6, 3, v6
    v_add_u32 v7, v7, v6
    s_lshl_b32 s60, s59, 2
    s_lshl_b32 s61, s58, 1
    s_xor_b32 s62, s61, 0
    s_add_u32 s62, s62, s60
    v_xor_b32 v6, s62, v8
    v_lshlrev_b32 v6, 5, v6
    v_add_u32 v146, v6, v7
    s_xor_b32 s62, s61, 1
    s_add_u32 s62, s62, s60
    v_xor_b32 v6, s62, v8
    v_lshlrev_b32 v6, 5, v6
    v_add_u32 v147, v6, v7
    s_xor_b32 s62, s61, 2
    s_add_u32 s62, s62, s60
    v_xor_b32 v6, s62, v8
    v_lshlrev_b32 v6, 5, v6
    v_add_u32 v148, v6, v7
    s_xor_b32 s62, s61, 3
    s_add_u32 s62, s62, s60
    v_xor_b32 v6, s62, v8
    v_lshlrev_b32 v6, 5, v6
    v_add_u32 v149, v6, v7
    v_lshlrev_b32 v184, 16, v210
    v_and_b32 v185, 0xffff0000, v210
    v_lshlrev_b32 v186, 16, v211
    v_and_b32 v187, 0xffff0000, v211
    v_lshlrev_b32 v188, 16, v212
    v_and_b32 v189, 0xffff0000, v212
    v_lshlrev_b32 v190, 16, v213
    v_and_b32 v191, 0xffff0000, v213
    v_lshlrev_b32 v192, 16, v214
    v_and_b32 v193, 0xffff0000, v214
    v_lshlrev_b32 v194, 16, v215
    v_and_b32 v195, 0xffff0000, v215
    v_lshlrev_b32 v196, 16, v216
    v_and_b32 v197, 0xffff0000, v216
    v_lshlrev_b32 v198, 16, v217
    v_and_b32 v199, 0xffff0000, v217
    s_mov_b32 s70, 0xbdd2d3e8
    s_mov_b32 s71, 0xbdd2d3e8
    v_mov_b32 v8, 0xc0135761
    v_mov_b32 v9, 0xc0135761
    v_lshlrev_b32 v10, 4, v2
    s_mul_i32 s66, s52, 0x100000
    s_add_u32 s66, s66, 0x100000
    s_lshl_b32 s60, s56, 3
    s_lshl_b32 s61, s58, 2
    s_add_u32 s60, s60, s61
    s_mul_i32 s60, s60, 55296
    s_add_u32 s66, s66, s60
    s_lshl_b32 s67, s57, 2
    s_lshl_b32 s60, s59, 1
    s_add_u32 s67, s67, s60
    s_xor_b32 s60, s58, 0
    s_add_u32 s60, s60, s67
    s_lshl_b32 s61, s60, 10
    s_add_u32 s61, s61, s66
    s_cmp_ge_u32 s60, 54
    s_cselect_b32 s72, 0x20000000, s61
    s_xor_b32 s60, s58, 1
    s_add_u32 s60, s60, s67
    s_lshl_b32 s61, s60, 10
    s_add_u32 s61, s61, s66
    s_cmp_ge_u32 s60, 54
    s_cselect_b32 s73, 0x20000000, s61
    v_mov_b32 v16, 0
    v_mov_b32 v17, 0
    v_mov_b32 v18, 0
    v_mov_b32 v19, 0
    v_mov_b32 v20, 0
    v_mov_b32 v21, 0
    v_mov_b32 v22, 0
    v_mov_b32 v23, 0
    v_mov_b32 v24, 0
    v_mov_b32 v25, 0
    v_mov_b32 v26, 0
    v_mov_b32 v27, 0
    v_mov_b32 v28, 0
    v_mov_b32 v29, 0
    v_mov_b32 v30, 0
    v_mov_b32 v31, 0
    v_mov_b32 v32, 0
    v_mov_b32 v33, 0
    v_mov_b32 v34, 0
    v_mov_b32 v35, 0
    v_mov_b32 v36, 0
    v_mov_b32 v37, 0
    v_mov_b32 v38, 0
    v_mov_b32 v39, 0
    v_mov_b32 v40, 0
    v_mov_b32 v41, 0
    v_mov_b32 v42, 0
    v_mov_b32 v43, 0
    v_mov_b32 v44, 0
    v_mov_b32 v45, 0
    v_mov_b32 v46, 0
    v_mov_b32 v47, 0
    v_mov_b32 v48, 0
    v_mov_b32 v49, 0
    v_mov_b32 v50, 0
    v_mov_b32 v51, 0
    v_mov_b32 v52, 0
    v_mov_b32 v53, 0
    v_mov_b32 v54, 0
    v_mov_b32 v55, 0
    v_mov_b32 v56, 0
    v_mov_b32 v57, 0
    v_mov_b32 v58, 0
    v_mov_b32 v59, 0
    v_mov_b32 v60, 0
    v_mov_b32 v61, 0
    v_mov_b32 v62, 0
    v_mov_b32 v63, 0
    v_mov_b32 v64, 0
    v_mov_b32 v65, 0
    v_mov_b32 v66, 0
    v_mov_b32 v67, 0
    v_mov_b32 v68, 0
    v_mov_b32 v69, 0
    v_mov_b32 v70, 0
    v_mov_b32 v71, 0
    v_mov_b32 v72, 0
    v_mov_b32 v73, 0
    v_mov_b32 v74, 0
    v_mov_b32 v75, 0
    v_mov_b32 v76, 0
    v_mov_b32 v77, 0
    v_mov_b32 v78, 0
    v_mov_b32 v79, 0
    v_mov_b32 v152, 0
    v_mov_b32 v153, 0
    v_mov_b32 v154, 0
    v_mov_b32 v155, 0
    v_mov_b32 v156, 0
    v_mov_b32 v157, 0
    v_mov_b32 v158, 0
    v_mov_b32 v159, 0
    v_mov_b32 v160, 0x3f803f80
    v_mov_b32 v161, 0x3f803f80
    v_mov_b32 v162, 0x3f803f80
    v_mov_b32 v163, 0x3f803f80
    s_mov_b32 s60, 0
    s_mov_b32 s62, 0
    s_mov_b32 s64, 0
    s_barrier
    ds_read_b128 v[80:83], v144 offset:0
    ds_read_b64_tr_b16 v[96:97], v146 offset:0
    ds_read_b64_tr_b16 v[98:99], v146 offset:1024
    ds_read_b128 v[84:87], v144 offset:1024
    ds_read_b64_tr_b16 v[100:101], v147 offset:0
    ds_read_b64_tr_b16 v[102:103], v147 offset:1024
    ds_read_b128 v[88:91], v144 offset:2048
    ds_read_b64_tr_b16 v[104:105], v148 offset:0
    ds_read_b64_tr_b16 v[106:107], v148 offset:1024
    ds_read_b128 v[92:95], v144 offset:3072
    ds_read_b64_tr_b16 v[108:109], v149 offset:0
    ds_read_b64_tr_b16 v[110:111], v149 offset:1024
p4_loop_122:
    s_waitcnt lgkmcnt(0)
    v_mfma_f32_16x16x32_bf16 v[16:19], v[96:99], v[80:83], v[16:19]
    ds_read_b128 v[112:115], v144 offset:8192
    s_add_u32 s60, s60, 1
    s_cmp_eq_u32 s60, 5
    v_mfma_f32_16x16x32_bf16 v[32:35], v[100:103], v[80:83], v[32:35]
    ds_read_b64_tr_b16 v[128:129], v146 offset:8192
    s_mov_b32 s61, 16384
    s_cselect_b32 s61, 0xffff0000, s61
    v_mfma_f32_16x16x32_bf16 v[48:51], v[104:107], v[80:83], v[48:51]
    ds_read_b64_tr_b16 v[130:131], v146 offset:9216
    s_cselect_b32 s60, 0, s60
    s_add_u32 s64, s64, 1
    v_mfma_f32_16x16x32_bf16 v[64:67], v[108:111], v[80:83], v[64:67]
    ds_read_b128 v[116:119], v144 offset:9216
    s_cmp_eq_u32 s64, 4
    s_mov_b32 s65, 16384
    v_mfma_f32_16x16x32_bf16 v[20:23], v[96:99], v[84:87], v[20:23]
    ds_read_b64_tr_b16 v[132:133], v147 offset:8192
    s_cselect_b32 s65, 0xffff4000, s65
    s_cselect_b32 s64, 0, s64
    v_mfma_f32_16x16x32_bf16 v[36:39], v[100:103], v[84:87], v[36:39]
    ds_read_b64_tr_b16 v[134:135], v147 offset:9216
    v_mfma_f32_16x16x32_bf16 v[52:55], v[104:107], v[84:87], v[52:55]
    ds_read_b128 v[120:123], v144 offset:10240
    v_mfma_f32_16x16x32_bf16 v[68:71], v[108:111], v[84:87], v[68:71]
    ds_read_b64_tr_b16 v[136:137], v148 offset:8192
    v_mfma_f32_16x16x32_bf16 v[24:27], v[96:99], v[88:91], v[24:27]
    ds_read_b64_tr_b16 v[138:139], v148 offset:9216
    v_mfma_f32_16x16x32_bf16 v[40:43], v[100:103], v[88:91], v[40:43]
    ds_read_b128 v[124:127], v144 offset:11264
    v_mfma_f32_16x16x32_bf16 v[56:59], v[104:107], v[88:91], v[56:59]
    ds_read_b64_tr_b16 v[140:141], v149 offset:8192
    v_mfma_f32_16x16x32_bf16 v[72:75], v[108:111], v[88:91], v[72:75]
    ds_read_b64_tr_b16 v[142:143], v149 offset:9216
    v_mfma_f32_16x16x32_bf16 v[28:31], v[96:99], v[92:95], v[28:31]
    v_add_u32 v144, s65, v144
    v_add_u32 v146, s61, v146
    v_add_u32 v147, s61, v147
    v_mfma_f32_16x16x32_bf16 v[44:47], v[100:103], v[92:95], v[44:47]
    v_add_u32 v148, s61, v148
    v_add_u32 v149, s61, v149
    s_add_u32 s62, s62, 1
    v_mfma_f32_16x16x32_bf16 v[152:155], v[96:99], v[160:163], v[152:155]
    v_mfma_f32_16x16x32_bf16 v[60:63], v[104:107], v[92:95], v[60:63]
    v_mfma_f32_16x16x32_bf16 v[76:79], v[108:111], v[92:95], v[76:79]
    v_mfma_f32_16x16x32_bf16 v[156:159], v[100:103], v[160:163], v[156:159]
    s_cmp_eq_u32 s62, 10
    s_waitcnt lgkmcnt(0)
    s_cbranch_scc1 p4_last_123
    v_mfma_f32_16x16x32_bf16 v[16:19], v[128:131], v[112:115], v[16:19]
    ds_read_b128 v[80:83], v144 offset:0
    v_mfma_f32_16x16x32_bf16 v[32:35], v[132:135], v[112:115], v[32:35]
    ds_read_b64_tr_b16 v[96:97], v146 offset:0
    v_mfma_f32_16x16x32_bf16 v[48:51], v[136:139], v[112:115], v[48:51]
    ds_read_b64_tr_b16 v[98:99], v146 offset:1024
    v_mfma_f32_16x16x32_bf16 v[64:67], v[140:143], v[112:115], v[64:67]
    ds_read_b128 v[84:87], v144 offset:1024
    v_mfma_f32_16x16x32_bf16 v[20:23], v[128:131], v[116:119], v[20:23]
    ds_read_b64_tr_b16 v[100:101], v147 offset:0
    v_mfma_f32_16x16x32_bf16 v[36:39], v[132:135], v[116:119], v[36:39]
    ds_read_b64_tr_b16 v[102:103], v147 offset:1024
    v_mfma_f32_16x16x32_bf16 v[52:55], v[136:139], v[116:119], v[52:55]
    ds_read_b128 v[88:91], v144 offset:2048
    v_mfma_f32_16x16x32_bf16 v[68:71], v[140:143], v[116:119], v[68:71]
    ds_read_b64_tr_b16 v[104:105], v148 offset:0
    v_mfma_f32_16x16x32_bf16 v[24:27], v[128:131], v[120:123], v[24:27]
    ds_read_b64_tr_b16 v[106:107], v148 offset:1024
    v_mfma_f32_16x16x32_bf16 v[40:43], v[132:135], v[120:123], v[40:43]
    ds_read_b128 v[92:95], v144 offset:3072
    v_mfma_f32_16x16x32_bf16 v[56:59], v[136:139], v[120:123], v[56:59]
    ds_read_b64_tr_b16 v[108:109], v149 offset:0
    v_mfma_f32_16x16x32_bf16 v[72:75], v[140:143], v[120:123], v[72:75]
    ds_read_b64_tr_b16 v[110:111], v149 offset:1024
    v_mfma_f32_16x16x32_bf16 v[28:31], v[128:131], v[124:127], v[28:31]
    v_mfma_f32_16x16x32_bf16 v[44:47], v[132:135], v[124:127], v[44:47]
    v_mfma_f32_16x16x32_bf16 v[152:155], v[128:131], v[160:163], v[152:155]
    v_mfma_f32_16x16x32_bf16 v[60:63], v[136:139], v[124:127], v[60:63]
    v_mfma_f32_16x16x32_bf16 v[76:79], v[140:143], v[124:127], v[76:79]
    v_mfma_f32_16x16x32_bf16 v[156:159], v[132:135], v[160:163], v[156:159]
    s_barrier
    s_branch p4_loop_122
p4_last_123:
    v_mfma_f32_16x16x32_bf16 v[16:19], v[128:131], v[112:115], v[16:19]
    v_mfma_f32_16x16x32_bf16 v[32:35], v[132:135], v[112:115], v[32:35]
    v_mfma_f32_16x16x32_bf16 v[48:51], v[136:139], v[112:115], v[48:51]
    v_mfma_f32_16x16x32_bf16 v[64:67], v[140:143], v[112:115], v[64:67]
    v_mfma_f32_16x16x32_bf16 v[20:23], v[128:131], v[116:119], v[20:23]
    v_mfma_f32_16x16x32_bf16 v[36:39], v[132:135], v[116:119], v[36:39]
    v_mfma_f32_16x16x32_bf16 v[52:55], v[136:139], v[116:119], v[52:55]
    v_mfma_f32_16x16x32_bf16 v[68:71], v[140:143], v[116:119], v[68:71]
    v_mfma_f32_16x16x32_bf16 v[24:27], v[128:131], v[120:123], v[24:27]
    v_mfma_f32_16x16x32_bf16 v[40:43], v[132:135], v[120:123], v[40:43]
    v_mfma_f32_16x16x32_bf16 v[56:59], v[136:139], v[120:123], v[56:59]
    v_mfma_f32_16x16x32_bf16 v[72:75], v[140:143], v[120:123], v[72:75]
    v_mfma_f32_16x16x32_bf16 v[28:31], v[128:131], v[124:127], v[28:31]
    v_mfma_f32_16x16x32_bf16 v[44:47], v[132:135], v[124:127], v[44:47]
    v_mfma_f32_16x16x32_bf16 v[152:155], v[128:131], v[160:163], v[152:155]
    v_mfma_f32_16x16x32_bf16 v[60:63], v[136:139], v[124:127], v[60:63]
    v_mfma_f32_16x16x32_bf16 v[76:79], v[140:143], v[124:127], v[76:79]
    v_mfma_f32_16x16x32_bf16 v[156:159], v[132:135], v[160:163], v[156:159]
p4_end_120:
    s_barrier
    v_lshrrev_b32 v3, 4, v2
    v_lshlrev_b32 v3, 4, v3
    s_lshl_b32 s60, s59, 2
    s_lshl_b32 s61, s58, 1
    s_mov_b64 s[66:67], exec
    s_xor_b32 s62, s61, 0
    s_add_u32 s62, s62, s60
    s_lshl_b32 s62, s62, 6
    s_add_u32 s62, s62, 161280
    v_add_u32 v4, s62, v3
    s_xor_b32 s62, s61, 1
    s_add_u32 s62, s62, s60
    s_lshl_b32 s62, s62, 6
    s_add_u32 s62, s62, 161280
    v_add_u32 v5, s62, v3
    s_mov_b32 exec_lo, 0x00010001
    s_mov_b32 exec_hi, 0x00010001
    ds_write_b128 v4, v[152:155]
    ds_write_b128 v5, v[156:159]
    s_mov_b64 exec, s[66:67]
    s_waitcnt lgkmcnt(0)
    s_barrier
    v_lshrrev_b32 v3, 4, v2
    v_lshlrev_b32 v3, 4, v3
    s_lshl_b32 s60, s59, 2
    s_lshl_b32 s61, s58, 1
    s_xor_b32 s62, s61, 0
    s_add_u32 s62, s62, s60
    s_lshl_b32 s62, s62, 6
    s_add_u32 s62, s62, 161280
    v_add_u32 v4, s62, v3
    ds_read_b128 v[80:83], v4
    s_xor_b32 s62, s61, 1
    s_add_u32 s62, s62, s60
    s_lshl_b32 s62, s62, 6
    s_add_u32 s62, s62, 161280
    v_add_u32 v4, s62, v3
    ds_read_b128 v[84:87], v4
    s_xor_b32 s62, s61, 2
    s_add_u32 s62, s62, s60
    s_lshl_b32 s62, s62, 6
    s_add_u32 s62, s62, 161280
    v_add_u32 v4, s62, v3
    ds_read_b128 v[88:91], v4
    s_xor_b32 s62, s61, 3
    s_add_u32 s62, s62, s60
    s_lshl_b32 s62, s62, 6
    s_add_u32 s62, s62, 161280
    v_add_u32 v4, s62, v3
    ds_read_b128 v[92:95], v4
    v_and_b32 v3, 15, v2
    v_lshlrev_b32 v3, 3, v3
    s_lshl_b32 s60, s58, 9
    s_add_u32 s60, s60, 160256
    v_add_u32 v3, s60, v3
    ds_read_b64 v[96:97], v3 offset:0
    ds_read_b64 v[98:99], v3 offset:128
    ds_read_b64 v[100:101], v3 offset:256
    ds_read_b64 v[102:103], v3 offset:384
    s_waitcnt lgkmcnt(0)
    v_pk_fma_f32 v[16:17], v[96:97], v[80:81], v[16:17] op_sel_hi:[0,1,1] neg_lo:[1,0,0] neg_hi:[1,0,0]
    v_pk_fma_f32 v[18:19], v[96:97], v[82:83], v[18:19] op_sel_hi:[0,1,1] neg_lo:[1,0,0] neg_hi:[1,0,0]
    v_pk_fma_f32 v[32:33], v[96:97], v[84:85], v[32:33] op_sel_hi:[0,1,1] neg_lo:[1,0,0] neg_hi:[1,0,0]
    v_pk_fma_f32 v[34:35], v[96:97], v[86:87], v[34:35] op_sel_hi:[0,1,1] neg_lo:[1,0,0] neg_hi:[1,0,0]
    v_pk_fma_f32 v[16:17], v[16:17], v[96:97], v[184:185] op_sel:[0,1,0] op_sel_hi:[1,1,1]
    v_pk_fma_f32 v[18:19], v[18:19], v[96:97], v[186:187] op_sel:[0,1,0] op_sel_hi:[1,1,1]
    v_pk_fma_f32 v[32:33], v[32:33], v[96:97], v[188:189] op_sel:[0,1,0] op_sel_hi:[1,1,1]
    v_pk_fma_f32 v[34:35], v[34:35], v[96:97], v[190:191] op_sel:[0,1,0] op_sel_hi:[1,1,1]
    v_pk_mul_f32 v[128:129], v[16:17], v[16:17]
    v_pk_mul_f32 v[130:131], v[18:19], v[18:19]
    v_pk_mul_f32 v[132:133], v[32:33], v[32:33]
    v_pk_mul_f32 v[134:135], v[34:35], v[34:35]
    v_pk_fma_f32 v[128:129], v[128:129], s[70:71], v[8:9]
    v_pk_fma_f32 v[130:131], v[130:131], s[70:71], v[8:9]
    v_pk_fma_f32 v[132:133], v[132:133], s[70:71], v[8:9]
    v_pk_fma_f32 v[134:135], v[134:135], s[70:71], v[8:9]
    v_pk_mul_f32 v[128:129], v[128:129], v[16:17]
    v_pk_mul_f32 v[130:131], v[130:131], v[18:19]
    v_pk_mul_f32 v[132:133], v[132:133], v[32:33]
    v_pk_mul_f32 v[134:135], v[134:135], v[34:35]
    v_exp_f32 v128, v128
    v_exp_f32 v129, v129
    v_exp_f32 v130, v130
    v_exp_f32 v131, v131
    v_exp_f32 v132, v132
    v_exp_f32 v133, v133
    v_exp_f32 v134, v134
    v_exp_f32 v135, v135
    v_pk_add_f32 v[128:129], v[128:129], 1.0 op_sel_hi:[1,0]
    v_pk_add_f32 v[130:131], v[130:131], 1.0 op_sel_hi:[1,0]
    v_pk_add_f32 v[132:133], v[132:133], 1.0 op_sel_hi:[1,0]
    v_pk_add_f32 v[134:135], v[134:135], 1.0 op_sel_hi:[1,0]
    v_rcp_f32 v128, v128
    v_rcp_f32 v129, v129
    v_rcp_f32 v130, v130
    v_rcp_f32 v131, v131
    v_rcp_f32 v132, v132
    v_rcp_f32 v133, v133
    v_rcp_f32 v134, v134
    v_rcp_f32 v135, v135
    v_pk_mul_f32 v[16:17], v[16:17], v[128:129]
    v_pk_mul_f32 v[18:19], v[18:19], v[130:131]
    v_pk_mul_f32 v[32:33], v[32:33], v[132:133]
    v_pk_mul_f32 v[34:35], v[34:35], v[134:135]
    v_cvt_pk_bf16_f32 v144, v16, v17
    v_cvt_pk_bf16_f32 v145, v18, v19
    v_cvt_pk_bf16_f32 v146, v32, v33
    v_cvt_pk_bf16_f32 v147, v34, v35
    buffer_store_dwordx4 v[144:147], v10, s[36:39], s72 offen
    s_add_u32 s72, s72, 55296
    v_pk_fma_f32 v[20:21], v[98:99], v[80:81], v[20:21] op_sel_hi:[0,1,1] neg_lo:[1,0,0] neg_hi:[1,0,0]
    v_pk_fma_f32 v[22:23], v[98:99], v[82:83], v[22:23] op_sel_hi:[0,1,1] neg_lo:[1,0,0] neg_hi:[1,0,0]
    v_pk_fma_f32 v[36:37], v[98:99], v[84:85], v[36:37] op_sel_hi:[0,1,1] neg_lo:[1,0,0] neg_hi:[1,0,0]
    v_pk_fma_f32 v[38:39], v[98:99], v[86:87], v[38:39] op_sel_hi:[0,1,1] neg_lo:[1,0,0] neg_hi:[1,0,0]
    v_pk_fma_f32 v[20:21], v[20:21], v[98:99], v[184:185] op_sel:[0,1,0] op_sel_hi:[1,1,1]
    v_pk_fma_f32 v[22:23], v[22:23], v[98:99], v[186:187] op_sel:[0,1,0] op_sel_hi:[1,1,1]
    v_pk_fma_f32 v[36:37], v[36:37], v[98:99], v[188:189] op_sel:[0,1,0] op_sel_hi:[1,1,1]
    v_pk_fma_f32 v[38:39], v[38:39], v[98:99], v[190:191] op_sel:[0,1,0] op_sel_hi:[1,1,1]
    v_pk_mul_f32 v[128:129], v[20:21], v[20:21]
    v_pk_mul_f32 v[130:131], v[22:23], v[22:23]
    v_pk_mul_f32 v[132:133], v[36:37], v[36:37]
    v_pk_mul_f32 v[134:135], v[38:39], v[38:39]
    v_pk_fma_f32 v[128:129], v[128:129], s[70:71], v[8:9]
    v_pk_fma_f32 v[130:131], v[130:131], s[70:71], v[8:9]
    v_pk_fma_f32 v[132:133], v[132:133], s[70:71], v[8:9]
    v_pk_fma_f32 v[134:135], v[134:135], s[70:71], v[8:9]
    v_pk_mul_f32 v[128:129], v[128:129], v[20:21]
    v_pk_mul_f32 v[130:131], v[130:131], v[22:23]
    v_pk_mul_f32 v[132:133], v[132:133], v[36:37]
    v_pk_mul_f32 v[134:135], v[134:135], v[38:39]
    v_exp_f32 v128, v128
    v_exp_f32 v129, v129
    v_exp_f32 v130, v130
    v_exp_f32 v131, v131
    v_exp_f32 v132, v132
    v_exp_f32 v133, v133
    v_exp_f32 v134, v134
    v_exp_f32 v135, v135
    v_pk_add_f32 v[128:129], v[128:129], 1.0 op_sel_hi:[1,0]
    v_pk_add_f32 v[130:131], v[130:131], 1.0 op_sel_hi:[1,0]
    v_pk_add_f32 v[132:133], v[132:133], 1.0 op_sel_hi:[1,0]
    v_pk_add_f32 v[134:135], v[134:135], 1.0 op_sel_hi:[1,0]
    v_rcp_f32 v128, v128
    v_rcp_f32 v129, v129
    v_rcp_f32 v130, v130
    v_rcp_f32 v131, v131
    v_rcp_f32 v132, v132
    v_rcp_f32 v133, v133
    v_rcp_f32 v134, v134
    v_rcp_f32 v135, v135
    v_pk_mul_f32 v[20:21], v[20:21], v[128:129]
    v_pk_mul_f32 v[22:23], v[22:23], v[130:131]
    v_pk_mul_f32 v[36:37], v[36:37], v[132:133]
    v_pk_mul_f32 v[38:39], v[38:39], v[134:135]
    v_cvt_pk_bf16_f32 v148, v20, v21
    v_cvt_pk_bf16_f32 v149, v22, v23
    v_cvt_pk_bf16_f32 v150, v36, v37
    v_cvt_pk_bf16_f32 v151, v38, v39
    buffer_store_dwordx4 v[148:151], v10, s[36:39], s72 offen
    s_add_u32 s72, s72, 55296
    v_pk_fma_f32 v[24:25], v[100:101], v[80:81], v[24:25] op_sel_hi:[0,1,1] neg_lo:[1,0,0] neg_hi:[1,0,0]
    v_pk_fma_f32 v[26:27], v[100:101], v[82:83], v[26:27] op_sel_hi:[0,1,1] neg_lo:[1,0,0] neg_hi:[1,0,0]
    v_pk_fma_f32 v[40:41], v[100:101], v[84:85], v[40:41] op_sel_hi:[0,1,1] neg_lo:[1,0,0] neg_hi:[1,0,0]
    v_pk_fma_f32 v[42:43], v[100:101], v[86:87], v[42:43] op_sel_hi:[0,1,1] neg_lo:[1,0,0] neg_hi:[1,0,0]
    v_pk_fma_f32 v[24:25], v[24:25], v[100:101], v[184:185] op_sel:[0,1,0] op_sel_hi:[1,1,1]
    v_pk_fma_f32 v[26:27], v[26:27], v[100:101], v[186:187] op_sel:[0,1,0] op_sel_hi:[1,1,1]
    v_pk_fma_f32 v[40:41], v[40:41], v[100:101], v[188:189] op_sel:[0,1,0] op_sel_hi:[1,1,1]
    v_pk_fma_f32 v[42:43], v[42:43], v[100:101], v[190:191] op_sel:[0,1,0] op_sel_hi:[1,1,1]
    v_pk_mul_f32 v[128:129], v[24:25], v[24:25]
    v_pk_mul_f32 v[130:131], v[26:27], v[26:27]
    v_pk_mul_f32 v[132:133], v[40:41], v[40:41]
    v_pk_mul_f32 v[134:135], v[42:43], v[42:43]
    v_pk_fma_f32 v[128:129], v[128:129], s[70:71], v[8:9]
    v_pk_fma_f32 v[130:131], v[130:131], s[70:71], v[8:9]
    v_pk_fma_f32 v[132:133], v[132:133], s[70:71], v[8:9]
    v_pk_fma_f32 v[134:135], v[134:135], s[70:71], v[8:9]
    v_pk_mul_f32 v[128:129], v[128:129], v[24:25]
    v_pk_mul_f32 v[130:131], v[130:131], v[26:27]
    v_pk_mul_f32 v[132:133], v[132:133], v[40:41]
    v_pk_mul_f32 v[134:135], v[134:135], v[42:43]
    v_exp_f32 v128, v128
    v_exp_f32 v129, v129
    v_exp_f32 v130, v130
    v_exp_f32 v131, v131
    v_exp_f32 v132, v132
    v_exp_f32 v133, v133
    v_exp_f32 v134, v134
    v_exp_f32 v135, v135
    v_pk_add_f32 v[128:129], v[128:129], 1.0 op_sel_hi:[1,0]
    v_pk_add_f32 v[130:131], v[130:131], 1.0 op_sel_hi:[1,0]
    v_pk_add_f32 v[132:133], v[132:133], 1.0 op_sel_hi:[1,0]
    v_pk_add_f32 v[134:135], v[134:135], 1.0 op_sel_hi:[1,0]
    v_rcp_f32 v128, v128
    v_rcp_f32 v129, v129
    v_rcp_f32 v130, v130
    v_rcp_f32 v131, v131
    v_rcp_f32 v132, v132
    v_rcp_f32 v133, v133
    v_rcp_f32 v134, v134
    v_rcp_f32 v135, v135
    v_pk_mul_f32 v[24:25], v[24:25], v[128:129]
    v_pk_mul_f32 v[26:27], v[26:27], v[130:131]
    v_pk_mul_f32 v[40:41], v[40:41], v[132:133]
    v_pk_mul_f32 v[42:43], v[42:43], v[134:135]
    v_cvt_pk_bf16_f32 v152, v24, v25
    v_cvt_pk_bf16_f32 v153, v26, v27
    v_cvt_pk_bf16_f32 v154, v40, v41
    v_cvt_pk_bf16_f32 v155, v42, v43
    buffer_store_dwordx4 v[152:155], v10, s[36:39], s72 offen
    s_add_u32 s72, s72, 55296
    v_pk_fma_f32 v[28:29], v[102:103], v[80:81], v[28:29] op_sel_hi:[0,1,1] neg_lo:[1,0,0] neg_hi:[1,0,0]
    v_pk_fma_f32 v[30:31], v[102:103], v[82:83], v[30:31] op_sel_hi:[0,1,1] neg_lo:[1,0,0] neg_hi:[1,0,0]
    v_pk_fma_f32 v[44:45], v[102:103], v[84:85], v[44:45] op_sel_hi:[0,1,1] neg_lo:[1,0,0] neg_hi:[1,0,0]
    v_pk_fma_f32 v[46:47], v[102:103], v[86:87], v[46:47] op_sel_hi:[0,1,1] neg_lo:[1,0,0] neg_hi:[1,0,0]
    v_pk_fma_f32 v[28:29], v[28:29], v[102:103], v[184:185] op_sel:[0,1,0] op_sel_hi:[1,1,1]
    v_pk_fma_f32 v[30:31], v[30:31], v[102:103], v[186:187] op_sel:[0,1,0] op_sel_hi:[1,1,1]
    v_pk_fma_f32 v[44:45], v[44:45], v[102:103], v[188:189] op_sel:[0,1,0] op_sel_hi:[1,1,1]
    v_pk_fma_f32 v[46:47], v[46:47], v[102:103], v[190:191] op_sel:[0,1,0] op_sel_hi:[1,1,1]
    v_pk_mul_f32 v[128:129], v[28:29], v[28:29]
    v_pk_mul_f32 v[130:131], v[30:31], v[30:31]
    v_pk_mul_f32 v[132:133], v[44:45], v[44:45]
    v_pk_mul_f32 v[134:135], v[46:47], v[46:47]
    v_pk_fma_f32 v[128:129], v[128:129], s[70:71], v[8:9]
    v_pk_fma_f32 v[130:131], v[130:131], s[70:71], v[8:9]
    v_pk_fma_f32 v[132:133], v[132:133], s[70:71], v[8:9]
    v_pk_fma_f32 v[134:135], v[134:135], s[70:71], v[8:9]
    v_pk_mul_f32 v[128:129], v[128:129], v[28:29]
    v_pk_mul_f32 v[130:131], v[130:131], v[30:31]
    v_pk_mul_f32 v[132:133], v[132:133], v[44:45]
    v_pk_mul_f32 v[134:135], v[134:135], v[46:47]
    v_exp_f32 v128, v128
    v_exp_f32 v129, v129
    v_exp_f32 v130, v130
    v_exp_f32 v131, v131
    v_exp_f32 v132, v132
    v_exp_f32 v133, v133
    v_exp_f32 v134, v134
    v_exp_f32 v135, v135
    v_pk_add_f32 v[128:129], v[128:129], 1.0 op_sel_hi:[1,0]
    v_pk_add_f32 v[130:131], v[130:131], 1.0 op_sel_hi:[1,0]
    v_pk_add_f32 v[132:133], v[132:133], 1.0 op_sel_hi:[1,0]
    v_pk_add_f32 v[134:135], v[134:135], 1.0 op_sel_hi:[1,0]
    v_rcp_f32 v128, v128
    v_rcp_f32 v129, v129
    v_rcp_f32 v130, v130
    v_rcp_f32 v131, v131
    v_rcp_f32 v132, v132
    v_rcp_f32 v133, v133
    v_rcp_f32 v134, v134
    v_rcp_f32 v135, v135
    v_pk_mul_f32 v[28:29], v[28:29], v[128:129]
    v_pk_mul_f32 v[30:31], v[30:31], v[130:131]
    v_pk_mul_f32 v[44:45], v[44:45], v[132:133]
    v_pk_mul_f32 v[46:47], v[46:47], v[134:135]
    v_cvt_pk_bf16_f32 v156, v28, v29
    v_cvt_pk_bf16_f32 v157, v30, v31
    v_cvt_pk_bf16_f32 v158, v44, v45
    v_cvt_pk_bf16_f32 v159, v46, v47
    buffer_store_dwordx4 v[156:159], v10, s[36:39], s72 offen
    v_pk_fma_f32 v[48:49], v[96:97], v[88:89], v[48:49] op_sel_hi:[0,1,1] neg_lo:[1,0,0] neg_hi:[1,0,0]
    v_pk_fma_f32 v[50:51], v[96:97], v[90:91], v[50:51] op_sel_hi:[0,1,1] neg_lo:[1,0,0] neg_hi:[1,0,0]
    v_pk_fma_f32 v[64:65], v[96:97], v[92:93], v[64:65] op_sel_hi:[0,1,1] neg_lo:[1,0,0] neg_hi:[1,0,0]
    v_pk_fma_f32 v[66:67], v[96:97], v[94:95], v[66:67] op_sel_hi:[0,1,1] neg_lo:[1,0,0] neg_hi:[1,0,0]
    v_pk_fma_f32 v[48:49], v[48:49], v[96:97], v[192:193] op_sel:[0,1,0] op_sel_hi:[1,1,1]
    v_pk_fma_f32 v[50:51], v[50:51], v[96:97], v[194:195] op_sel:[0,1,0] op_sel_hi:[1,1,1]
    v_pk_fma_f32 v[64:65], v[64:65], v[96:97], v[196:197] op_sel:[0,1,0] op_sel_hi:[1,1,1]
    v_pk_fma_f32 v[66:67], v[66:67], v[96:97], v[198:199] op_sel:[0,1,0] op_sel_hi:[1,1,1]
    v_pk_mul_f32 v[128:129], v[48:49], v[48:49]
    v_pk_mul_f32 v[130:131], v[50:51], v[50:51]
    v_pk_mul_f32 v[132:133], v[64:65], v[64:65]
    v_pk_mul_f32 v[134:135], v[66:67], v[66:67]
    v_pk_fma_f32 v[128:129], v[128:129], s[70:71], v[8:9]
    v_pk_fma_f32 v[130:131], v[130:131], s[70:71], v[8:9]
    v_pk_fma_f32 v[132:133], v[132:133], s[70:71], v[8:9]
    v_pk_fma_f32 v[134:135], v[134:135], s[70:71], v[8:9]
    v_pk_mul_f32 v[128:129], v[128:129], v[48:49]
    v_pk_mul_f32 v[130:131], v[130:131], v[50:51]
    v_pk_mul_f32 v[132:133], v[132:133], v[64:65]
    v_pk_mul_f32 v[134:135], v[134:135], v[66:67]
    v_exp_f32 v128, v128
    v_exp_f32 v129, v129
    v_exp_f32 v130, v130
    v_exp_f32 v131, v131
    v_exp_f32 v132, v132
    v_exp_f32 v133, v133
    v_exp_f32 v134, v134
    v_exp_f32 v135, v135
    v_pk_add_f32 v[128:129], v[128:129], 1.0 op_sel_hi:[1,0]
    v_pk_add_f32 v[130:131], v[130:131], 1.0 op_sel_hi:[1,0]
    v_pk_add_f32 v[132:133], v[132:133], 1.0 op_sel_hi:[1,0]
    v_pk_add_f32 v[134:135], v[134:135], 1.0 op_sel_hi:[1,0]
    v_rcp_f32 v128, v128
    v_rcp_f32 v129, v129
    v_rcp_f32 v130, v130
    v_rcp_f32 v131, v131
    v_rcp_f32 v132, v132
    v_rcp_f32 v133, v133
    v_rcp_f32 v134, v134
    v_rcp_f32 v135, v135
    v_pk_mul_f32 v[48:49], v[48:49], v[128:129]
    v_pk_mul_f32 v[50:51], v[50:51], v[130:131]
    v_pk_mul_f32 v[64:65], v[64:65], v[132:133]
    v_pk_mul_f32 v[66:67], v[66:67], v[134:135]
    v_cvt_pk_bf16_f32 v160, v48, v49
    v_cvt_pk_bf16_f32 v161, v50, v51
    v_cvt_pk_bf16_f32 v162, v64, v65
    v_cvt_pk_bf16_f32 v163, v66, v67
    buffer_store_dwordx4 v[160:163], v10, s[36:39], s73 offen
    s_add_u32 s73, s73, 55296
    v_pk_fma_f32 v[52:53], v[98:99], v[88:89], v[52:53] op_sel_hi:[0,1,1] neg_lo:[1,0,0] neg_hi:[1,0,0]
    v_pk_fma_f32 v[54:55], v[98:99], v[90:91], v[54:55] op_sel_hi:[0,1,1] neg_lo:[1,0,0] neg_hi:[1,0,0]
    v_pk_fma_f32 v[68:69], v[98:99], v[92:93], v[68:69] op_sel_hi:[0,1,1] neg_lo:[1,0,0] neg_hi:[1,0,0]
    v_pk_fma_f32 v[70:71], v[98:99], v[94:95], v[70:71] op_sel_hi:[0,1,1] neg_lo:[1,0,0] neg_hi:[1,0,0]
    v_pk_fma_f32 v[52:53], v[52:53], v[98:99], v[192:193] op_sel:[0,1,0] op_sel_hi:[1,1,1]
    v_pk_fma_f32 v[54:55], v[54:55], v[98:99], v[194:195] op_sel:[0,1,0] op_sel_hi:[1,1,1]
    v_pk_fma_f32 v[68:69], v[68:69], v[98:99], v[196:197] op_sel:[0,1,0] op_sel_hi:[1,1,1]
    v_pk_fma_f32 v[70:71], v[70:71], v[98:99], v[198:199] op_sel:[0,1,0] op_sel_hi:[1,1,1]
    v_pk_mul_f32 v[128:129], v[52:53], v[52:53]
    v_pk_mul_f32 v[130:131], v[54:55], v[54:55]
    v_pk_mul_f32 v[132:133], v[68:69], v[68:69]
    v_pk_mul_f32 v[134:135], v[70:71], v[70:71]
    v_pk_fma_f32 v[128:129], v[128:129], s[70:71], v[8:9]
    v_pk_fma_f32 v[130:131], v[130:131], s[70:71], v[8:9]
    v_pk_fma_f32 v[132:133], v[132:133], s[70:71], v[8:9]
    v_pk_fma_f32 v[134:135], v[134:135], s[70:71], v[8:9]
    v_pk_mul_f32 v[128:129], v[128:129], v[52:53]
    v_pk_mul_f32 v[130:131], v[130:131], v[54:55]
    v_pk_mul_f32 v[132:133], v[132:133], v[68:69]
    v_pk_mul_f32 v[134:135], v[134:135], v[70:71]
    v_exp_f32 v128, v128
    v_exp_f32 v129, v129
    v_exp_f32 v130, v130
    v_exp_f32 v131, v131
    v_exp_f32 v132, v132
    v_exp_f32 v133, v133
    v_exp_f32 v134, v134
    v_exp_f32 v135, v135
    v_pk_add_f32 v[128:129], v[128:129], 1.0 op_sel_hi:[1,0]
    v_pk_add_f32 v[130:131], v[130:131], 1.0 op_sel_hi:[1,0]
    v_pk_add_f32 v[132:133], v[132:133], 1.0 op_sel_hi:[1,0]
    v_pk_add_f32 v[134:135], v[134:135], 1.0 op_sel_hi:[1,0]
    v_rcp_f32 v128, v128
    v_rcp_f32 v129, v129
    v_rcp_f32 v130, v130
    v_rcp_f32 v131, v131
    v_rcp_f32 v132, v132
    v_rcp_f32 v133, v133
    v_rcp_f32 v134, v134
    v_rcp_f32 v135, v135
    v_pk_mul_f32 v[52:53], v[52:53], v[128:129]
    v_pk_mul_f32 v[54:55], v[54:55], v[130:131]
    v_pk_mul_f32 v[68:69], v[68:69], v[132:133]
    v_pk_mul_f32 v[70:71], v[70:71], v[134:135]
    v_cvt_pk_bf16_f32 v164, v52, v53
    v_cvt_pk_bf16_f32 v165, v54, v55
    v_cvt_pk_bf16_f32 v166, v68, v69
    v_cvt_pk_bf16_f32 v167, v70, v71
    buffer_store_dwordx4 v[164:167], v10, s[36:39], s73 offen
    s_add_u32 s73, s73, 55296
    v_pk_fma_f32 v[56:57], v[100:101], v[88:89], v[56:57] op_sel_hi:[0,1,1] neg_lo:[1,0,0] neg_hi:[1,0,0]
    v_pk_fma_f32 v[58:59], v[100:101], v[90:91], v[58:59] op_sel_hi:[0,1,1] neg_lo:[1,0,0] neg_hi:[1,0,0]
    v_pk_fma_f32 v[72:73], v[100:101], v[92:93], v[72:73] op_sel_hi:[0,1,1] neg_lo:[1,0,0] neg_hi:[1,0,0]
    v_pk_fma_f32 v[74:75], v[100:101], v[94:95], v[74:75] op_sel_hi:[0,1,1] neg_lo:[1,0,0] neg_hi:[1,0,0]
    v_pk_fma_f32 v[56:57], v[56:57], v[100:101], v[192:193] op_sel:[0,1,0] op_sel_hi:[1,1,1]
    v_pk_fma_f32 v[58:59], v[58:59], v[100:101], v[194:195] op_sel:[0,1,0] op_sel_hi:[1,1,1]
    v_pk_fma_f32 v[72:73], v[72:73], v[100:101], v[196:197] op_sel:[0,1,0] op_sel_hi:[1,1,1]
    v_pk_fma_f32 v[74:75], v[74:75], v[100:101], v[198:199] op_sel:[0,1,0] op_sel_hi:[1,1,1]
    v_pk_mul_f32 v[128:129], v[56:57], v[56:57]
    v_pk_mul_f32 v[130:131], v[58:59], v[58:59]
    v_pk_mul_f32 v[132:133], v[72:73], v[72:73]
    v_pk_mul_f32 v[134:135], v[74:75], v[74:75]
    v_pk_fma_f32 v[128:129], v[128:129], s[70:71], v[8:9]
    v_pk_fma_f32 v[130:131], v[130:131], s[70:71], v[8:9]
    v_pk_fma_f32 v[132:133], v[132:133], s[70:71], v[8:9]
    v_pk_fma_f32 v[134:135], v[134:135], s[70:71], v[8:9]
    v_pk_mul_f32 v[128:129], v[128:129], v[56:57]
    v_pk_mul_f32 v[130:131], v[130:131], v[58:59]
    v_pk_mul_f32 v[132:133], v[132:133], v[72:73]
    v_pk_mul_f32 v[134:135], v[134:135], v[74:75]
    v_exp_f32 v128, v128
    v_exp_f32 v129, v129
    v_exp_f32 v130, v130
    v_exp_f32 v131, v131
    v_exp_f32 v132, v132
    v_exp_f32 v133, v133
    v_exp_f32 v134, v134
    v_exp_f32 v135, v135
    v_pk_add_f32 v[128:129], v[128:129], 1.0 op_sel_hi:[1,0]
    v_pk_add_f32 v[130:131], v[130:131], 1.0 op_sel_hi:[1,0]
    v_pk_add_f32 v[132:133], v[132:133], 1.0 op_sel_hi:[1,0]
    v_pk_add_f32 v[134:135], v[134:135], 1.0 op_sel_hi:[1,0]
    v_rcp_f32 v128, v128
    v_rcp_f32 v129, v129
    v_rcp_f32 v130, v130
    v_rcp_f32 v131, v131
    v_rcp_f32 v132, v132
    v_rcp_f32 v133, v133
    v_rcp_f32 v134, v134
    v_rcp_f32 v135, v135
    v_pk_mul_f32 v[56:57], v[56:57], v[128:129]
    v_pk_mul_f32 v[58:59], v[58:59], v[130:131]
    v_pk_mul_f32 v[72:73], v[72:73], v[132:133]
    v_pk_mul_f32 v[74:75], v[74:75], v[134:135]
    v_cvt_pk_bf16_f32 v168, v56, v57
    v_cvt_pk_bf16_f32 v169, v58, v59
    v_cvt_pk_bf16_f32 v170, v72, v73
    v_cvt_pk_bf16_f32 v171, v74, v75
    buffer_store_dwordx4 v[168:171], v10, s[36:39], s73 offen
    s_add_u32 s73, s73, 55296
    v_pk_fma_f32 v[60:61], v[102:103], v[88:89], v[60:61] op_sel_hi:[0,1,1] neg_lo:[1,0,0] neg_hi:[1,0,0]
    v_pk_fma_f32 v[62:63], v[102:103], v[90:91], v[62:63] op_sel_hi:[0,1,1] neg_lo:[1,0,0] neg_hi:[1,0,0]
    v_pk_fma_f32 v[76:77], v[102:103], v[92:93], v[76:77] op_sel_hi:[0,1,1] neg_lo:[1,0,0] neg_hi:[1,0,0]
    v_pk_fma_f32 v[78:79], v[102:103], v[94:95], v[78:79] op_sel_hi:[0,1,1] neg_lo:[1,0,0] neg_hi:[1,0,0]
    v_pk_fma_f32 v[60:61], v[60:61], v[102:103], v[192:193] op_sel:[0,1,0] op_sel_hi:[1,1,1]
    v_pk_fma_f32 v[62:63], v[62:63], v[102:103], v[194:195] op_sel:[0,1,0] op_sel_hi:[1,1,1]
    v_pk_fma_f32 v[76:77], v[76:77], v[102:103], v[196:197] op_sel:[0,1,0] op_sel_hi:[1,1,1]
    v_pk_fma_f32 v[78:79], v[78:79], v[102:103], v[198:199] op_sel:[0,1,0] op_sel_hi:[1,1,1]
    v_pk_mul_f32 v[128:129], v[60:61], v[60:61]
    v_pk_mul_f32 v[130:131], v[62:63], v[62:63]
    v_pk_mul_f32 v[132:133], v[76:77], v[76:77]
    v_pk_mul_f32 v[134:135], v[78:79], v[78:79]
    v_pk_fma_f32 v[128:129], v[128:129], s[70:71], v[8:9]
    v_pk_fma_f32 v[130:131], v[130:131], s[70:71], v[8:9]
    v_pk_fma_f32 v[132:133], v[132:133], s[70:71], v[8:9]
    v_pk_fma_f32 v[134:135], v[134:135], s[70:71], v[8:9]
    v_pk_mul_f32 v[128:129], v[128:129], v[60:61]
    v_pk_mul_f32 v[130:131], v[130:131], v[62:63]
    v_pk_mul_f32 v[132:133], v[132:133], v[76:77]
    v_pk_mul_f32 v[134:135], v[134:135], v[78:79]
    v_exp_f32 v128, v128
    v_exp_f32 v129, v129
    v_exp_f32 v130, v130
    v_exp_f32 v131, v131
    v_exp_f32 v132, v132
    v_exp_f32 v133, v133
    v_exp_f32 v134, v134
    v_exp_f32 v135, v135
    v_pk_add_f32 v[128:129], v[128:129], 1.0 op_sel_hi:[1,0]
    v_pk_add_f32 v[130:131], v[130:131], 1.0 op_sel_hi:[1,0]
    v_pk_add_f32 v[132:133], v[132:133], 1.0 op_sel_hi:[1,0]
    v_pk_add_f32 v[134:135], v[134:135], 1.0 op_sel_hi:[1,0]
    v_rcp_f32 v128, v128
    v_rcp_f32 v129, v129
    v_rcp_f32 v130, v130
    v_rcp_f32 v131, v131
    v_rcp_f32 v132, v132
    v_rcp_f32 v133, v133
    v_rcp_f32 v134, v134
    v_rcp_f32 v135, v135
    v_pk_mul_f32 v[60:61], v[60:61], v[128:129]
    v_pk_mul_f32 v[62:63], v[62:63], v[130:131]
    v_pk_mul_f32 v[76:77], v[76:77], v[132:133]
    v_pk_mul_f32 v[78:79], v[78:79], v[134:135]
    v_cvt_pk_bf16_f32 v172, v60, v61
    v_cvt_pk_bf16_f32 v173, v62, v63
    v_cvt_pk_bf16_f32 v174, v76, v77
    v_cvt_pk_bf16_f32 v175, v78, v79
    buffer_store_dwordx4 v[172:175], v10, s[36:39], s73 offen
    s_waitcnt vmcnt(0)
    v_mov_b32 v3, 161792
    v_mov_b32 v4, 1
    s_mov_b64 exec, 1
    ds_add_u32 v3, v4
    s_mov_b64 exec, -1
    s_branch L_p4_end
L_p4_np:
    s_cmp_ge_u32 s54, 6
    s_cbranch_scc1 L_p4_sv
    s_add_u32 s60, s70, s66
    s_mov_b32 m0, s60
    s_add_u32 s61, s64, 0
    buffer_load_dwordx4 v16, s[36:39], s61 offen  lds
    s_add_u32 s60, s60, 1024
    s_mov_b32 m0, s60
    s_add_u32 s61, s64, 20480
    buffer_load_dwordx4 v16, s[36:39], s61 offen  lds
    s_add_u32 s60, s60, 1024
    s_mov_b32 m0, s60
    s_add_u32 s61, s64, 40960
    buffer_load_dwordx4 v16, s[36:39], s61 offen  lds
    s_add_u32 s60, s60, 1024
    s_mov_b32 m0, s60
    s_add_u32 s61, s64, 61440
    buffer_load_dwordx4 v16, s[36:39], s61 offen  lds
    s_add_u32 s60, s60, 1024
    s_mov_b32 m0, s60
    s_add_u32 s61, s64, 81920
    buffer_load_dwordx4 v16, s[36:39], s61 offen  lds
    s_add_u32 s60, s60, 1024
    s_mov_b32 m0, s60
    s_add_u32 s61, s64, 102400
    buffer_load_dwordx4 v16, s[36:39], s61 offen  lds
    s_add_u32 s60, s60, 1024
    s_mov_b32 m0, s60
    s_add_u32 s61, s64, 122880
    buffer_load_dwordx4 v16, s[36:39], s61 offen  lds
    s_add_u32 s60, s60, 1024
    s_mov_b32 m0, s60
    s_add_u32 s61, s64, 143360
    buffer_load_dwordx4 v16, s[36:39], s61 offen  lds
    s_add_u32 s64, s64, 2048
    s_add_u32 s70, s70, 16384
    s_cmp_eq_u32 s70, 65536
    s_cselect_b32 s70, 0, s70
    s_add_u32 s60, s70, s66
    s_mov_b32 m0, s60
    s_add_u32 s61, s64, 0
    buffer_load_dwordx4 v16, s[36:39], s61 offen  lds
    s_add_u32 s60, s60, 1024
    s_mov_b32 m0, s60
    s_add_u32 s61, s64, 20480
    buffer_load_dwordx4 v16, s[36:39], s61 offen  lds
    s_add_u32 s60, s60, 1024
    s_mov_b32 m0, s60
    s_add_u32 s61, s64, 40960
    buffer_load_dwordx4 v16, s[36:39], s61 offen  lds
    s_add_u32 s60, s60, 1024
    s_mov_b32 m0, s60
    s_add_u32 s61, s64, 61440
    buffer_load_dwordx4 v16, s[36:39], s61 offen  lds
    s_add_u32 s60, s60, 1024
    s_mov_b32 m0, s60
    s_add_u32 s61, s64, 81920
    buffer_load_dwordx4 v16, s[36:39], s61 offen  lds
    s_add_u32 s60, s60, 1024
    s_mov_b32 m0, s60
    s_add_u32 s61, s64, 102400
    buffer_load_dwordx4 v16, s[36:39], s61 offen  lds
    s_add_u32 s60, s60, 1024
    s_mov_b32 m0, s60
    s_add_u32 s61, s64, 122880
    buffer_load_dwordx4 v16, s[36:39], s61 offen  lds
    s_add_u32 s60, s60, 1024
    s_mov_b32 m0, s60
    s_add_u32 s61, s64, 143360
    buffer_load_dwordx4 v16, s[36:39], s61 offen  lds
    s_add_u32 s64, s64, 2048
    s_add_u32 s70, s70, 16384
    s_cmp_eq_u32 s70, 65536
    s_cselect_b32 s70, 0, s70
    s_add_u32 s60, s70, s66
    s_mov_b32 m0, s60
    s_add_u32 s61, s64, 0
    buffer_load_dwordx4 v16, s[36:39], s61 offen  lds
    s_add_u32 s60, s60, 1024
    s_mov_b32 m0, s60
    s_add_u32 s61, s64, 20480
    buffer_load_dwordx4 v16, s[36:39], s61 offen  lds
    s_add_u32 s60, s60, 1024
    s_mov_b32 m0, s60
    s_add_u32 s61, s64, 40960
    buffer_load_dwordx4 v16, s[36:39], s61 offen  lds
    s_add_u32 s60, s60, 1024
    s_mov_b32 m0, s60
    s_add_u32 s61, s64, 61440
    buffer_load_dwordx4 v16, s[36:39], s61 offen  lds
    s_add_u32 s60, s60, 1024
    s_mov_b32 m0, s60
    s_add_u32 s61, s64, 81920
    buffer_load_dwordx4 v16, s[36:39], s61 offen  lds
    s_add_u32 s60, s60, 1024
    s_mov_b32 m0, s60
    s_add_u32 s61, s64, 102400
    buffer_load_dwordx4 v16, s[36:39], s61 offen  lds
    s_add_u32 s60, s60, 1024
    s_mov_b32 m0, s60
    s_add_u32 s61, s64, 122880
    buffer_load_dwordx4 v16, s[36:39], s61 offen  lds
    s_add_u32 s60, s60, 1024
    s_mov_b32 m0, s60
    s_add_u32 s61, s64, 143360
    buffer_load_dwordx4 v16, s[36:39], s61 offen  lds
    s_add_u32 s64, s64, 2048
    s_add_u32 s70, s70, 16384
    s_cmp_eq_u32 s70, 65536
    s_cselect_b32 s70, 0, s70
    s_waitcnt vmcnt(8)
    s_barrier
    s_add_u32 s60, s70, s66
    s_mov_b32 m0, s60
    s_add_u32 s61, s64, 0
    buffer_load_dwordx4 v16, s[36:39], s61 offen  lds
    s_add_u32 s60, s60, 1024
    s_mov_b32 m0, s60
    s_add_u32 s61, s64, 20480
    buffer_load_dwordx4 v16, s[36:39], s61 offen  lds
    s_add_u32 s60, s60, 1024
    s_mov_b32 m0, s60
    s_add_u32 s61, s64, 40960
    buffer_load_dwordx4 v16, s[36:39], s61 offen  lds
    s_add_u32 s60, s60, 1024
    s_mov_b32 m0, s60
    s_add_u32 s61, s64, 61440
    buffer_load_dwordx4 v16, s[36:39], s61 offen  lds
    s_add_u32 s60, s60, 1024
    s_mov_b32 m0, s60
    s_add_u32 s61, s64, 81920
    buffer_load_dwordx4 v16, s[36:39], s61 offen  lds
    s_add_u32 s60, s60, 1024
    s_mov_b32 m0, s60
    s_add_u32 s61, s64, 102400
    buffer_load_dwordx4 v16, s[36:39], s61 offen  lds
    s_add_u32 s60, s60, 1024
    s_mov_b32 m0, s60
    s_add_u32 s61, s64, 122880
    buffer_load_dwordx4 v16, s[36:39], s61 offen  lds
    s_add_u32 s60, s60, 1024
    s_mov_b32 m0, s60
    s_add_u32 s61, s64, 143360
    buffer_load_dwordx4 v16, s[36:39], s61 offen  lds
    s_add_u32 s64, s64, 2048
    s_add_u32 s70, s70, 16384
    s_cmp_eq_u32 s70, 65536
    s_cselect_b32 s70, 0, s70
    s_add_u32 s60, s68, s67
    s_mov_b32 m0, s60
    s_add_u32 s61, s65, 0
    buffer_load_dwordx4 v17, s[32:35], s61 offen lds
    s_add_u32 s60, s68, s67
    s_add_u32 s60, s60, 1024
    s_mov_b32 m0, s60
    s_add_u32 s61, s65, 13824
    buffer_load_dwordx4 v17, s[32:35], s61 offen lds
    s_add_u32 s60, s68, s67
    s_add_u32 s60, s60, 4096
    s_mov_b32 m0, s60
    s_add_u32 s61, s65, 55296
    buffer_load_dwordx4 v17, s[32:35], s61 offen lds
    s_add_u32 s60, s68, s67
    s_add_u32 s60, s60, 5120
    s_mov_b32 m0, s60
    s_add_u32 s61, s65, 69120
    buffer_load_dwordx4 v17, s[32:35], s61 offen lds
    s_add_u32 s60, s68, s67
    s_add_u32 s60, s60, 8192
    s_mov_b32 m0, s60
    s_add_u32 s61, s65, 110592
    buffer_load_dwordx4 v17, s[32:35], s61 offen lds
    s_add_u32 s60, s68, s67
    s_add_u32 s60, s60, 9216
    s_mov_b32 m0, s60
    s_add_u32 s61, s65, 124416
    buffer_load_dwordx4 v17, s[32:35], s61 offen lds
    s_add_u32 s60, s68, s67
    s_add_u32 s60, s60, 12288
    s_mov_b32 m0, s60
    s_add_u32 s61, s65, 165888
    buffer_load_dwordx4 v17, s[32:35], s61 offen lds
    s_add_u32 s60, s68, s67
    s_add_u32 s60, s60, 13312
    s_mov_b32 m0, s60
    s_add_u32 s61, s65, 179712
    buffer_load_dwordx4 v17, s[32:35], s61 offen lds
    s_add_u32 s65, s65, 221184
    s_add_u32 s68, s68, 16384
    s_cmp_eq_u32 s68, 81920
    s_cselect_b32 s68, 0, s68
    s_waitcnt vmcnt(16)
    s_barrier
    s_mov_b32 s69, 0
p4p_124:
    s_add_u32 s60, s70, s66
    s_mov_b32 m0, s60
    s_add_u32 s61, s64, 0
    buffer_load_dwordx4 v16, s[36:39], s61 offen  lds
    s_add_u32 s60, s60, 1024
    s_mov_b32 m0, s60
    s_add_u32 s61, s64, 20480
    buffer_load_dwordx4 v16, s[36:39], s61 offen  lds
    s_add_u32 s60, s60, 1024
    s_mov_b32 m0, s60
    s_add_u32 s61, s64, 40960
    buffer_load_dwordx4 v16, s[36:39], s61 offen  lds
    s_add_u32 s60, s60, 1024
    s_mov_b32 m0, s60
    s_add_u32 s61, s64, 61440
    buffer_load_dwordx4 v16, s[36:39], s61 offen  lds
    s_add_u32 s60, s60, 1024
    s_mov_b32 m0, s60
    s_add_u32 s61, s64, 81920
    buffer_load_dwordx4 v16, s[36:39], s61 offen  lds
    s_add_u32 s60, s60, 1024
    s_mov_b32 m0, s60
    s_add_u32 s61, s64, 102400
    buffer_load_dwordx4 v16, s[36:39], s61 offen  lds
    s_add_u32 s60, s60, 1024
    s_mov_b32 m0, s60
    s_add_u32 s61, s64, 122880
    buffer_load_dwordx4 v16, s[36:39], s61 offen  lds
    s_add_u32 s60, s60, 1024
    s_mov_b32 m0, s60
    s_add_u32 s61, s64, 143360
    buffer_load_dwordx4 v16, s[36:39], s61 offen  lds
    s_add_u32 s64, s64, 2048
    s_add_u32 s70, s70, 16384
    s_cmp_eq_u32 s70, 65536
    s_cselect_b32 s70, 0, s70
    s_add_u32 s60, s68, s67
    s_mov_b32 m0, s60
    s_add_u32 s61, s65, 0
    buffer_load_dwordx4 v17, s[32:35], s61 offen lds
    s_add_u32 s60, s68, s67
    s_add_u32 s60, s60, 1024
    s_mov_b32 m0, s60
    s_add_u32 s61, s65, 13824
    buffer_load_dwordx4 v17, s[32:35], s61 offen lds
    s_add_u32 s60, s68, s67
    s_add_u32 s60, s60, 4096
    s_mov_b32 m0, s60
    s_add_u32 s61, s65, 55296
    buffer_load_dwordx4 v17, s[32:35], s61 offen lds
    s_add_u32 s60, s68, s67
    s_add_u32 s60, s60, 5120
    s_mov_b32 m0, s60
    s_add_u32 s61, s65, 69120
    buffer_load_dwordx4 v17, s[32:35], s61 offen lds
    s_add_u32 s60, s68, s67
    s_add_u32 s60, s60, 8192
    s_mov_b32 m0, s60
    s_add_u32 s61, s65, 110592
    buffer_load_dwordx4 v17, s[32:35], s61 offen lds
    s_add_u32 s60, s68, s67
    s_add_u32 s60, s60, 9216
    s_mov_b32 m0, s60
    s_add_u32 s61, s65, 124416
    buffer_load_dwordx4 v17, s[32:35], s61 offen lds
    s_add_u32 s60, s68, s67
    s_add_u32 s60, s60, 12288
    s_mov_b32 m0, s60
    s_add_u32 s61, s65, 165888
    buffer_load_dwordx4 v17, s[32:35], s61 offen lds
    s_add_u32 s60, s68, s67
    s_add_u32 s60, s60, 13312
    s_mov_b32 m0, s60
    s_add_u32 s61, s65, 179712
    buffer_load_dwordx4 v17, s[32:35], s61 offen lds
    s_add_u32 s65, s65, 221184
    s_add_u32 s68, s68, 16384
    s_cmp_eq_u32 s68, 81920
    s_cselect_b32 s68, 0, s68
    s_waitcnt vmcnt(24)
    s_barrier
    s_add_u32 s69, s69, 1
    s_cmp_lt_u32 s69, 5
    s_cbranch_scc1 p4p_124
    s_add_u32 s60, s70, s66
    s_mov_b32 m0, s60
    s_add_u32 s61, s64, 0
    buffer_load_dwordx4 v16, s[36:39], s61 offen  lds
    s_add_u32 s60, s60, 1024
    s_mov_b32 m0, s60
    s_add_u32 s61, s64, 20480
    buffer_load_dwordx4 v16, s[36:39], s61 offen  lds
    s_add_u32 s60, s60, 1024
    s_mov_b32 m0, s60
    s_add_u32 s61, s64, 40960
    buffer_load_dwordx4 v16, s[36:39], s61 offen  lds
    s_add_u32 s60, s60, 1024
    s_mov_b32 m0, s60
    s_add_u32 s61, s64, 61440
    buffer_load_dwordx4 v16, s[36:39], s61 offen  lds
    s_add_u32 s60, s60, 1024
    s_mov_b32 m0, s60
    s_add_u32 s61, s64, 81920
    buffer_load_dwordx4 v16, s[36:39], s61 offen  lds
    s_add_u32 s60, s60, 1024
    s_mov_b32 m0, s60
    s_add_u32 s61, s64, 102400
    buffer_load_dwordx4 v16, s[36:39], s61 offen  lds
    s_add_u32 s60, s60, 1024
    s_mov_b32 m0, s60
    s_add_u32 s61, s64, 122880
    buffer_load_dwordx4 v16, s[36:39], s61 offen  lds
    s_add_u32 s60, s60, 1024
    s_mov_b32 m0, s60
    s_add_u32 s61, s64, 143360
    buffer_load_dwordx4 v16, s[36:39], s61 offen  lds
    s_add_u32 s64, s64, 2048
    s_add_u32 s70, s70, 16384
    s_cmp_eq_u32 s70, 65536
    s_cselect_b32 s70, 0, s70
    s_waitcnt vmcnt(16)
    s_barrier
    s_waitcnt vmcnt(0)
    s_barrier
    s_barrier
    s_barrier
    v_lshlrev_b32 v4, 4, v2
    s_mov_b32 s65, 0x2000
    buffer_load_dwordx4 v[6:9], v4, s[36:39], s65 offen sc1
    s_barrier
    s_waitcnt vmcnt(0)
    v_min_u32 v6, v6, v7
    v_min_u32 v8, v8, v9
    v_min_u32 v6, v6, v8
    v_cmp_gt_u32 vcc, 2, v6
    s_mov_b32 s60, 0
    s_mov_b32 s61, 0xff000000
    s_nop 0
    s_and_b64 vcc, vcc, s[60:61]
    s_cbranch_vccz L_p4_pf
L_p4_late:
    v_lshlrev_b32 v4, 4, v2
    s_mov_b32 s65, 0x2000
    s_mov_b32 s92, 0
rw_125:
    buffer_load_dwordx4 v[6:9], v4, s[36:39], s65 offen sc1
    s_waitcnt vmcnt(0)
    v_min_u32 v6, v6, v7
    v_min_u32 v8, v8, v9
    v_min_u32 v6, v6, v8
    v_cmp_gt_u32 vcc, 2, v6
    s_mov_b32 s60, 0
    s_mov_b32 s61, 0xff000000
    s_nop 0
    s_and_b64 vcc, vcc, s[60:61]
    s_cbranch_vccz rwd_126
    s_sleep 8
    s_add_u32 s92, s92, 1
    s_cmp_lt_u32 s92, 0x40000
    s_cbranch_scc1 rw_125
rwd_126:
L_p4_pf:
    s_sub_u32 s63, s54, 4
    v_lshlrev_b32 v16, 4, v2
    s_lshr_b32 s64, s53, 2
    s_mul_i32 s64, s64, 276480
    s_add_u32 s64, s64, 0x2100000
    s_mul_i32 s60, s63, 138240
    s_add_u32 s64, s64, s60
    s_mul_i32 s66, s63, 15360
    s_mov_b32 s68, 0
    s_mov_b32 s69, 0
pfl_127:
    s_add_u32 s60, s68, s66
    s_mov_b32 m0, s60
    s_add_u32 s60, s60, 1024
    buffer_load_dwordx4 v16, s[36:39], s64 offen sc1 lds
    s_add_u32 s64, s64, 1024
    s_mov_b32 m0, s60
    s_add_u32 s60, s60, 1024
    buffer_load_dwordx4 v16, s[36:39], s64 offen sc1 lds
    s_add_u32 s64, s64, 1024
    s_mov_b32 m0, s60
    s_add_u32 s60, s60, 1024
    buffer_load_dwordx4 v16, s[36:39], s64 offen sc1 lds
    s_add_u32 s64, s64, 1024
    s_mov_b32 m0, s60
    s_add_u32 s60, s60, 1024
    buffer_load_dwordx4 v16, s[36:39], s64 offen sc1 lds
    s_add_u32 s64, s64, 1024
    s_mov_b32 m0, s60
    s_add_u32 s60, s60, 1024
    buffer_load_dwordx4 v16, s[36:39], s64 offen sc1 lds
    s_add_u32 s64, s64, 1024
    s_mov_b32 m0, s60
    s_add_u32 s60, s60, 1024
    buffer_load_dwordx4 v16, s[36:39], s64 offen sc1 lds
    s_add_u32 s64, s64, 1024
    s_mov_b32 m0, s60
    s_add_u32 s60, s60, 1024
    buffer_load_dwordx4 v16, s[36:39], s64 offen sc1 lds
    s_add_u32 s64, s64, 1024
    s_mov_b32 m0, s60
    s_add_u32 s60, s60, 1024
    buffer_load_dwordx4 v16, s[36:39], s64 offen sc1 lds
    s_add_u32 s64, s64, 1024
    s_mov_b32 m0, s60
    s_add_u32 s60, s60, 1024
    buffer_load_dwordx4 v16, s[36:39], s64 offen sc1 lds
    s_add_u32 s64, s64, 1024
    s_mov_b32 m0, s60
    s_add_u32 s60, s60, 1024
    buffer_load_dwordx4 v16, s[36:39], s64 offen sc1 lds
    s_add_u32 s64, s64, 1024
    s_mov_b32 m0, s60
    s_add_u32 s60, s60, 1024
    buffer_load_dwordx4 v16, s[36:39], s64 offen sc1 lds
    s_add_u32 s64, s64, 1024
    s_mov_b32 m0, s60
    s_add_u32 s60, s60, 1024
    buffer_load_dwordx4 v16, s[36:39], s64 offen sc1 lds
    s_add_u32 s64, s64, 1024
    s_mov_b32 m0, s60
    s_add_u32 s60, s60, 1024
    buffer_load_dwordx4 v16, s[36:39], s64 offen sc1 lds
    s_add_u32 s64, s64, 1024
    s_mov_b32 m0, s60
    s_add_u32 s60, s60, 1024
    buffer_load_dwordx4 v16, s[36:39], s64 offen sc1 lds
    s_add_u32 s64, s64, 1024
    s_mov_b32 m0, s60
    s_nop 0
    buffer_load_dwordx4 v16, s[36:39], s64 offen sc1 lds
    s_add_u32 s64, s64, 1024
    s_add_u32 s68, s68, 30720
    s_cmp_eq_u32 s68, 153600
    s_cselect_b32 s68, 0, s68
    s_add_u32 s69, s69, 1
    s_cmp_lt_u32 s69, 5
    s_cbranch_scc1 pfl_127
    s_branch L_p4_end
L_p4_sv:
    s_cmp_eq_u32 s54, 7
    s_cbranch_scc1 L_p4_sp
    v_mov_b32 v3, 161792
    v_mov_b32 v4, 0
    ds_write_b32 v3, v4
    s_waitcnt lgkmcnt(0)
    s_lshl_b32 s60, s52, 14
    s_lshl_b32 s61, s56, 10
    s_add_u32 s60, s60, s61
    s_add_u32 s60, s60, 0x20000
    v_lshlrev_b32 v3, 4, v2
    s_barrier
    s_barrier
    s_barrier
    buffer_load_dwordx4 v[16:19], v3, s[36:39], s60 offen offset:0
    buffer_load_dwordx4 v[20:23], v3, s[36:39], s60 offen offset:2048
    s_add_u32 s60, s60, 4096
    buffer_load_dwordx4 v[24:27], v3, s[36:39], s60 offen offset:0
    buffer_load_dwordx4 v[28:31], v3, s[36:39], s60 offen offset:2048
    s_add_u32 s60, s60, 4096
    buffer_load_dwordx4 v[32:35], v3, s[36:39], s60 offen offset:0
    buffer_load_dwordx4 v[36:39], v3, s[36:39], s60 offen offset:2048
    s_add_u32 s60, s60, 4096
    buffer_load_dwordx4 v[40:43], v3, s[36:39], s60 offen offset:0
    buffer_load_dwordx4 v[44:47], v3, s[36:39], s60 offen offset:2048
    s_barrier
    s_barrier
    s_barrier
    s_waitcnt vmcnt(0)
    v_add_f32 v16, v16, v20
    v_add_f32 v17, v17, v21
    v_add_f32 v18, v18, v22
    v_add_f32 v19, v19, v23
    v_add_f32 v16, v16, v24
    v_add_f32 v17, v17, v25
    v_add_f32 v18, v18, v26
    v_add_f32 v19, v19, v27
    v_add_f32 v16, v16, v28
    v_add_f32 v17, v17, v29
    v_add_f32 v18, v18, v30
    v_add_f32 v19, v19, v31
    v_add_f32 v16, v16, v32
    v_add_f32 v17, v17, v33
    v_add_f32 v18, v18, v34
    v_add_f32 v19, v19, v35
    v_add_f32 v16, v16, v36
    v_add_f32 v17, v17, v37
    v_add_f32 v18, v18, v38
    v_add_f32 v19, v19, v39
    v_add_f32 v16, v16, v40
    v_add_f32 v17, v17, v41
    v_add_f32 v18, v18, v42
    v_add_f32 v19, v19, v43
    v_add_f32 v16, v16, v44
    v_add_f32 v17, v17, v45
    v_add_f32 v18, v18, v46
    v_add_f32 v19, v19, v47
    s_barrier
    v_mul_f32 v16, 0x3acccccd, v16
    v_mul_f32 v17, 0x3acccccd, v17
    v_fma_f32 v17, -v16, v16, v17
    v_max_f32 v17, 0, v17
    v_add_f32 v17, 0x3727c5ac, v17
    v_rsq_f32 v17, v17
    v_mul_f32 v18, 0x3acccccd, v18
    v_mul_f32 v19, 0x3acccccd, v19
    v_fma_f32 v19, -v18, v18, v19
    v_max_f32 v19, 0, v19
    v_add_f32 v19, 0x3727c5ac, v19
    v_rsq_f32 v19, v19
    v_add_u32 v3, 160256, v3
    ds_write_b128 v3, v[16:19]
    s_waitcnt lgkmcnt(0)
    s_barrier
    s_barrier
    v_and_b32 v3, 31, v2
    v_lshlrev_b32 v3, 2, v3
    s_lshl_b32 s64, s52, 8
    s_add_u32 s65, s64, 0x3000
    s_cmp_eq_u32 s52, 7
    s_cselect_b32 s65, s64, s65
    buffer_load_dword v5, v3, s[36:39], s64 offen sc1
    buffer_load_dword v6, v3, s[36:39], s65 offen sc1
    s_barrier
    s_barrier
    s_mov_b32 s92, 0
    s_branch hcc_130
hc_128:
    buffer_load_dword v5, v3, s[36:39], s64 offen sc1
    buffer_load_dword v6, v3, s[36:39], s65 offen sc1
hcc_130:
    s_waitcnt vmcnt(0)
    v_cmp_gt_u32 vcc, 4, v5
    v_cmp_gt_u32 s[60:61], 1, v6
    s_nop 2
    s_or_b64 vcc, vcc, s[60:61]
    s_cbranch_vccz hd_129
    s_sleep 8
    s_add_u32 s92, s92, 1
    s_cmp_lt_u32 s92, 0x40000
    s_cbranch_scc1 hc_128
hd_129:
    s_barrier
    v_mov_b32 v3, 161792
    s_mov_b32 s92, 0
v1w_131:
    s_sleep 1
    ds_read_b32 v4, v3
    s_waitcnt lgkmcnt(0)
    v_readfirstlane_b32 s60, v4
    s_add_u32 s92, s92, 1
    s_cmp_ge_u32 s92, 0x400000
    s_cbranch_scc1 L_p4_end
    s_cmp_lt_u32 s60, 4
    s_cbranch_scc1 v1w_131
    s_branch L_p4_end
L_p4_sp:
    s_barrier
    s_barrier
    s_barrier
    s_barrier
    s_barrier
    s_barrier
    s_barrier
    s_barrier
    s_barrier
    s_barrier
    s_barrier
    s_waitcnt vmcnt(0)
    s_barrier
    s_branch L_p4_end
L_p4_idle:
    s_lshl_b32 s76, s52, 2
    s_add_u32 s76, s76, s53
    s_sub_u32 s76, s76, 28
    s_lshl_b32 s76, s76, 3
    s_add_u32 s76, s76, s54
    s_mul_i32 s77, s54, 12288
    v_lshrrev_b32 v3, 3, v2
    v_and_b32 v4, 7, v2
    v_lshlrev_b32 v4, 4, v4
    v_lshrrev_b32 v9, 2, v3
    v_and_b32 v10, 3, v3
    s_mov_b32 s80, s16
    s_mov_b32 s81, s17
    s_mov_b32 s82, 0x21c000
    s_mov_b32 s83, 0x00020000
    s_add_u32 s66, s76, 0
    s_mul_hi_u32 s67, s66, 0x1999999a
    s_mul_i32 s60, s67, 10
    s_sub_u32 s70, s66, s60
    s_mul_i32 s84, s67, 5120
    s_add_u32 s84, s84, 0x2100000
    s_cmp_ge_u32 s66, 540
    s_cselect_b32 s84, 0x20000000, s84
    s_lshl_b32 s60, s67, 5
    s_add_u32 s60, s60, 0
    v_add_u32 v12, s60, v3
    s_lshl_b32 s60, s67, 5
    s_add_u32 s60, s60, 8
    v_add_u32 v13, s60, v3
    s_lshl_b32 s60, s67, 5
    s_add_u32 s60, s60, 16
    v_add_u32 v14, s60, v3
    s_lshl_b32 s60, s67, 5
    s_add_u32 s60, s60, 24
    v_add_u32 v15, s60, v3
    s_lshl_b32 s60, s70, 7
    v_add_u32 v11, s60, v4
    v_mul_u32_u24 v12, 1280, v12
    v_add_u32 v12, v12, v11
    v_mul_u32_u24 v13, 1280, v13
    v_add_u32 v13, v13, v11
    v_mul_u32_u24 v14, 1280, v14
    v_add_u32 v14, v14, v11
    v_mul_u32_u24 v15, 1280, v15
    v_add_u32 v15, v15, v11
    s_add_u32 s60, s77, 0
    s_mov_b32 m0, s60
    s_nop 0
    buffer_load_dwordx4 v12, s[80:83], 0 offen lds
    s_add_u32 s60, s77, 1024
    s_mov_b32 m0, s60
    s_nop 0
    buffer_load_dwordx4 v13, s[80:83], 0 offen lds
    s_add_u32 s60, s77, 2048
    s_mov_b32 m0, s60
    s_nop 0
    buffer_load_dwordx4 v14, s[80:83], 0 offen lds
    s_add_u32 s60, s77, 3072
    s_mov_b32 m0, s60
    s_nop 0
    buffer_load_dwordx4 v15, s[80:83], 0 offen lds
    s_add_u32 s66, s76, 256
    s_mul_hi_u32 s67, s66, 0x1999999a
    s_mul_i32 s60, s67, 10
    s_sub_u32 s71, s66, s60
    s_mul_i32 s85, s67, 5120
    s_add_u32 s85, s85, 0x2100000
    s_cmp_ge_u32 s66, 540
    s_cselect_b32 s85, 0x20000000, s85
    s_lshl_b32 s60, s67, 5
    s_add_u32 s60, s60, 0
    v_add_u32 v12, s60, v3
    s_lshl_b32 s60, s67, 5
    s_add_u32 s60, s60, 8
    v_add_u32 v13, s60, v3
    s_lshl_b32 s60, s67, 5
    s_add_u32 s60, s60, 16
    v_add_u32 v14, s60, v3
    s_lshl_b32 s60, s67, 5
    s_add_u32 s60, s60, 24
    v_add_u32 v15, s60, v3
    s_lshl_b32 s60, s71, 7
    v_add_u32 v11, s60, v4
    v_mul_u32_u24 v12, 1280, v12
    v_add_u32 v12, v12, v11
    v_mul_u32_u24 v13, 1280, v13
    v_add_u32 v13, v13, v11
    v_mul_u32_u24 v14, 1280, v14
    v_add_u32 v14, v14, v11
    v_mul_u32_u24 v15, 1280, v15
    v_add_u32 v15, v15, v11
    s_add_u32 s60, s77, 4096
    s_mov_b32 m0, s60
    s_nop 0
    buffer_load_dwordx4 v12, s[80:83], 0 offen lds
    s_add_u32 s60, s77, 5120
    s_mov_b32 m0, s60
    s_nop 0
    buffer_load_dwordx4 v13, s[80:83], 0 offen lds
    s_add_u32 s60, s77, 6144
    s_mov_b32 m0, s60
    s_nop 0
    buffer_load_dwordx4 v14, s[80:83], 0 offen lds
    s_add_u32 s60, s77, 7168
    s_mov_b32 m0, s60
    s_nop 0
    buffer_load_dwordx4 v15, s[80:83], 0 offen lds
    s_add_u32 s66, s76, 512
    s_mul_hi_u32 s67, s66, 0x1999999a
    s_mul_i32 s60, s67, 10
    s_sub_u32 s72, s66, s60
    s_mul_i32 s86, s67, 5120
    s_add_u32 s86, s86, 0x2100000
    s_cmp_ge_u32 s66, 540
    s_cselect_b32 s86, 0x20000000, s86
    s_lshl_b32 s60, s67, 5
    s_add_u32 s60, s60, 0
    v_add_u32 v12, s60, v3
    s_lshl_b32 s60, s67, 5
    s_add_u32 s60, s60, 8
    v_add_u32 v13, s60, v3
    s_lshl_b32 s60, s67, 5
    s_add_u32 s60, s60, 16
    v_add_u32 v14, s60, v3
    s_lshl_b32 s60, s67, 5
    s_add_u32 s60, s60, 24
    v_add_u32 v15, s60, v3
    s_lshl_b32 s60, s72, 7
    v_add_u32 v11, s60, v4
    v_mul_u32_u24 v12, 1280, v12
    v_add_u32 v12, v12, v11
    v_mul_u32_u24 v13, 1280, v13
    v_add_u32 v13, v13, v11
    v_mul_u32_u24 v14, 1280, v14
    v_add_u32 v14, v14, v11
    v_mul_u32_u24 v15, 1280, v15
    v_add_u32 v15, v15, v11
    s_add_u32 s60, s77, 8192
    s_mov_b32 m0, s60
    s_nop 0
    buffer_load_dwordx4 v12, s[80:83], 0 offen lds
    s_add_u32 s60, s77, 9216
    s_mov_b32 m0, s60
    s_nop 0
    buffer_load_dwordx4 v13, s[80:83], 0 offen lds
    s_add_u32 s60, s77, 10240
    s_mov_b32 m0, s60
    s_nop 0
    buffer_load_dwordx4 v14, s[80:83], 0 offen lds
    s_add_u32 s60, s77, 11264
    s_mov_b32 m0, s60
    s_nop 0
    buffer_load_dwordx4 v15, s[80:83], 0 offen lds
    s_waitcnt vmcnt(0)
    v_lshlrev_b32 v8, 4, v2
    v_lshrrev_b32 v5, 4, v2
    v_and_b32 v7, 15, v2
    v_lshrrev_b32 v11, 2, v7
    v_and_b32 v7, 3, v7
    v_lshlrev_b32 v5, 2, v5
    v_add_u32 v5, v5, v11
    v_lshlrev_b32 v5, 7, v5
    v_lshlrev_b32 v7, 3, v7
    v_add_u32 v5, v5, v7
    v_add_u32 v5, s77, v5
    ds_read_b64_tr_b16 v[160:161], v5 offset:0
    ds_read_b64_tr_b16 v[162:163], v5 offset:2048
    ds_read_b64_tr_b16 v[164:165], v5 offset:32
    ds_read_b64_tr_b16 v[166:167], v5 offset:2080
    ds_read_b64_tr_b16 v[168:169], v5 offset:64
    ds_read_b64_tr_b16 v[170:171], v5 offset:2112
    ds_read_b64_tr_b16 v[172:173], v5 offset:96
    ds_read_b64_tr_b16 v[174:175], v5 offset:2144
    ds_read_b64_tr_b16 v[176:177], v5 offset:4096
    ds_read_b64_tr_b16 v[178:179], v5 offset:6144
    ds_read_b64_tr_b16 v[180:181], v5 offset:4128
    ds_read_b64_tr_b16 v[182:183], v5 offset:6176
    ds_read_b64_tr_b16 v[184:185], v5 offset:4160
    ds_read_b64_tr_b16 v[186:187], v5 offset:6208
    ds_read_b64_tr_b16 v[188:189], v5 offset:4192
    ds_read_b64_tr_b16 v[190:191], v5 offset:6240
    ds_read_b64_tr_b16 v[192:193], v5 offset:8192
    ds_read_b64_tr_b16 v[194:195], v5 offset:10240
    ds_read_b64_tr_b16 v[196:197], v5 offset:8224
    ds_read_b64_tr_b16 v[198:199], v5 offset:10272
    ds_read_b64_tr_b16 v[200:201], v5 offset:8256
    ds_read_b64_tr_b16 v[202:203], v5 offset:10304
    ds_read_b64_tr_b16 v[204:205], v5 offset:8288
    ds_read_b64_tr_b16 v[206:207], v5 offset:10336
    s_waitcnt lgkmcnt(0)
    s_lshl_b32 s60, s70, 2
    s_add_u32 s60, s60, 0
    s_mul_i32 s61, s60, 52429
    s_lshr_b32 s61, s61, 18
    s_mul_i32 s62, s61, 5
    s_sub_u32 s62, s60, s62
    s_and_b32 s63, s61, 1
    s_add_u32 s62, s62, 5
    s_sub_u32 s62, s62, s63
    s_cmp_ge_u32 s62, 5
    s_cselect_b32 s63, 5, 0
    s_sub_u32 s62, s62, s63
    s_mul_i32 s61, s61, 276480
    s_lshl_b32 s62, s62, 10
    s_add_u32 s61, s61, s62
    s_add_u32 s61, s61, s84
    buffer_store_dwordx4 v[160:163], v8, s[36:39], s61 offen sc0 sc1
    s_lshl_b32 s60, s70, 2
    s_add_u32 s60, s60, 1
    s_mul_i32 s61, s60, 52429
    s_lshr_b32 s61, s61, 18
    s_mul_i32 s62, s61, 5
    s_sub_u32 s62, s60, s62
    s_and_b32 s63, s61, 1
    s_add_u32 s62, s62, 5
    s_sub_u32 s62, s62, s63
    s_cmp_ge_u32 s62, 5
    s_cselect_b32 s63, 5, 0
    s_sub_u32 s62, s62, s63
    s_mul_i32 s61, s61, 276480
    s_lshl_b32 s62, s62, 10
    s_add_u32 s61, s61, s62
    s_add_u32 s61, s61, s84
    buffer_store_dwordx4 v[164:167], v8, s[36:39], s61 offen sc0 sc1
    s_lshl_b32 s60, s70, 2
    s_add_u32 s60, s60, 2
    s_mul_i32 s61, s60, 52429
    s_lshr_b32 s61, s61, 18
    s_mul_i32 s62, s61, 5
    s_sub_u32 s62, s60, s62
    s_and_b32 s63, s61, 1
    s_add_u32 s62, s62, 5
    s_sub_u32 s62, s62, s63
    s_cmp_ge_u32 s62, 5
    s_cselect_b32 s63, 5, 0
    s_sub_u32 s62, s62, s63
    s_mul_i32 s61, s61, 276480
    s_lshl_b32 s62, s62, 10
    s_add_u32 s61, s61, s62
    s_add_u32 s61, s61, s84
    buffer_store_dwordx4 v[168:171], v8, s[36:39], s61 offen sc0 sc1
    s_lshl_b32 s60, s70, 2
    s_add_u32 s60, s60, 3
    s_mul_i32 s61, s60, 52429
    s_lshr_b32 s61, s61, 18
    s_mul_i32 s62, s61, 5
    s_sub_u32 s62, s60, s62
    s_and_b32 s63, s61, 1
    s_add_u32 s62, s62, 5
    s_sub_u32 s62, s62, s63
    s_cmp_ge_u32 s62, 5
    s_cselect_b32 s63, 5, 0
    s_sub_u32 s62, s62, s63
    s_mul_i32 s61, s61, 276480
    s_lshl_b32 s62, s62, 10
    s_add_u32 s61, s61, s62
    s_add_u32 s61, s61, s84
    buffer_store_dwordx4 v[172:175], v8, s[36:39], s61 offen sc0 sc1
    s_lshl_b32 s60, s71, 2
    s_add_u32 s60, s60, 0
    s_mul_i32 s61, s60, 52429
    s_lshr_b32 s61, s61, 18
    s_mul_i32 s62, s61, 5
    s_sub_u32 s62, s60, s62
    s_and_b32 s63, s61, 1
    s_add_u32 s62, s62, 5
    s_sub_u32 s62, s62, s63
    s_cmp_ge_u32 s62, 5
    s_cselect_b32 s63, 5, 0
    s_sub_u32 s62, s62, s63
    s_mul_i32 s61, s61, 276480
    s_lshl_b32 s62, s62, 10
    s_add_u32 s61, s61, s62
    s_add_u32 s61, s61, s85
    buffer_store_dwordx4 v[176:179], v8, s[36:39], s61 offen sc0 sc1
    s_lshl_b32 s60, s71, 2
    s_add_u32 s60, s60, 1
    s_mul_i32 s61, s60, 52429
    s_lshr_b32 s61, s61, 18
    s_mul_i32 s62, s61, 5
    s_sub_u32 s62, s60, s62
    s_and_b32 s63, s61, 1
    s_add_u32 s62, s62, 5
    s_sub_u32 s62, s62, s63
    s_cmp_ge_u32 s62, 5
    s_cselect_b32 s63, 5, 0
    s_sub_u32 s62, s62, s63
    s_mul_i32 s61, s61, 276480
    s_lshl_b32 s62, s62, 10
    s_add_u32 s61, s61, s62
    s_add_u32 s61, s61, s85
    buffer_store_dwordx4 v[180:183], v8, s[36:39], s61 offen sc0 sc1
    s_lshl_b32 s60, s71, 2
    s_add_u32 s60, s60, 2
    s_mul_i32 s61, s60, 52429
    s_lshr_b32 s61, s61, 18
    s_mul_i32 s62, s61, 5
    s_sub_u32 s62, s60, s62
    s_and_b32 s63, s61, 1
    s_add_u32 s62, s62, 5
    s_sub_u32 s62, s62, s63
    s_cmp_ge_u32 s62, 5
    s_cselect_b32 s63, 5, 0
    s_sub_u32 s62, s62, s63
    s_mul_i32 s61, s61, 276480
    s_lshl_b32 s62, s62, 10
    s_add_u32 s61, s61, s62
    s_add_u32 s61, s61, s85
    buffer_store_dwordx4 v[184:187], v8, s[36:39], s61 offen sc0 sc1
    s_lshl_b32 s60, s71, 2
    s_add_u32 s60, s60, 3
    s_mul_i32 s61, s60, 52429
    s_lshr_b32 s61, s61, 18
    s_mul_i32 s62, s61, 5
    s_sub_u32 s62, s60, s62
    s_and_b32 s63, s61, 1
    s_add_u32 s62, s62, 5
    s_sub_u32 s62, s62, s63
    s_cmp_ge_u32 s62, 5
    s_cselect_b32 s63, 5, 0
    s_sub_u32 s62, s62, s63
    s_mul_i32 s61, s61, 276480
    s_lshl_b32 s62, s62, 10
    s_add_u32 s61, s61, s62
    s_add_u32 s61, s61, s85
    buffer_store_dwordx4 v[188:191], v8, s[36:39], s61 offen sc0 sc1
    s_lshl_b32 s60, s72, 2
    s_add_u32 s60, s60, 0
    s_mul_i32 s61, s60, 52429
    s_lshr_b32 s61, s61, 18
    s_mul_i32 s62, s61, 5
    s_sub_u32 s62, s60, s62
    s_and_b32 s63, s61, 1
    s_add_u32 s62, s62, 5
    s_sub_u32 s62, s62, s63
    s_cmp_ge_u32 s62, 5
    s_cselect_b32 s63, 5, 0
    s_sub_u32 s62, s62, s63
    s_mul_i32 s61, s61, 276480
    s_lshl_b32 s62, s62, 10
    s_add_u32 s61, s61, s62
    s_add_u32 s61, s61, s86
    buffer_store_dwordx4 v[192:195], v8, s[36:39], s61 offen sc0 sc1
    s_lshl_b32 s60, s72, 2
    s_add_u32 s60, s60, 1
    s_mul_i32 s61, s60, 52429
    s_lshr_b32 s61, s61, 18
    s_mul_i32 s62, s61, 5
    s_sub_u32 s62, s60, s62
    s_and_b32 s63, s61, 1
    s_add_u32 s62, s62, 5
    s_sub_u32 s62, s62, s63
    s_cmp_ge_u32 s62, 5
    s_cselect_b32 s63, 5, 0
    s_sub_u32 s62, s62, s63
    s_mul_i32 s61, s61, 276480
    s_lshl_b32 s62, s62, 10
    s_add_u32 s61, s61, s62
    s_add_u32 s61, s61, s86
    buffer_store_dwordx4 v[196:199], v8, s[36:39], s61 offen sc0 sc1
    s_lshl_b32 s60, s72, 2
    s_add_u32 s60, s60, 2
    s_mul_i32 s61, s60, 52429
    s_lshr_b32 s61, s61, 18
    s_mul_i32 s62, s61, 5
    s_sub_u32 s62, s60, s62
    s_and_b32 s63, s61, 1
    s_add_u32 s62, s62, 5
    s_sub_u32 s62, s62, s63
    s_cmp_ge_u32 s62, 5
    s_cselect_b32 s63, 5, 0
    s_sub_u32 s62, s62, s63
    s_mul_i32 s61, s61, 276480
    s_lshl_b32 s62, s62, 10
    s_add_u32 s61, s61, s62
    s_add_u32 s61, s61, s86
    buffer_store_dwordx4 v[200:203], v8, s[36:39], s61 offen sc0 sc1
    s_lshl_b32 s60, s72, 2
    s_add_u32 s60, s60, 3
    s_mul_i32 s61, s60, 52429
    s_lshr_b32 s61, s61, 18
    s_mul_i32 s62, s61, 5
    s_sub_u32 s62, s60, s62
    s_and_b32 s63, s61, 1
    s_add_u32 s62, s62, 5
    s_sub_u32 s62, s62, s63
    s_cmp_ge_u32 s62, 5
    s_cselect_b32 s63, 5, 0
    s_sub_u32 s62, s62, s63
    s_mul_i32 s61, s61, 276480
    s_lshl_b32 s62, s62, 10
    s_add_u32 s61, s61, s62
    s_add_u32 s61, s61, s86
    buffer_store_dwordx4 v[204:207], v8, s[36:39], s61 offen sc0 sc1
    s_waitcnt vmcnt(0)
    s_barrier
    s_cmp_lg_u32 s54, 6
    s_cbranch_scc1 pi6_132
    s_lshl_b32 s60, s2, 2
    s_add_u32 s60, s60, 0x2000
    v_mov_b32 v3, 2
    v_mov_b32 v4, 0
    s_mov_b64 s[62:63], exec
    s_mov_b64 exec, 1
    buffer_store_dword v3, v4, s[36:39], s60 offen sc0 sc1
    s_mov_b64 exec, s[62:63]
    s_branch L_p4_end
pi6_132:
    s_cmp_lt_u32 s54, 4
    s_cbranch_scc1 L_p4_end
    s_cmp_ge_u32 s54, 6
    s_cbranch_scc1 L_p4_end
    s_branch L_p4_late
L_p4_end:
    s_cmp_ge_u32 s54, 4
    s_cbranch_scc1 p5x_133
    s_and_b32 s56, s53, 3
    s_lshr_b32 s57, s53, 2
    s_and_b32 s74, s57, 1
    s_lshl_b32 s75, s56, 2
    s_lshl_b32 s60, s58, 1
    s_add_u32 s75, s75, s60
    s_add_u32 s76, s75, 1
    s_sub_u32 s76, s76, s59
    s_add_u32 s75, s75, s59
    v_lshlrev_b32 v6, 4, v2
    s_mul_i32 s64, s52, 0x100000
    s_add_u32 s64, s64, 0x100000
    s_mul_i32 s60, s59, 27648
    s_add_u32 s64, s64, s60
    s_mul_i32 s65, s75, 55296
    s_add_u32 s65, s65, s64
    s_mul_i32 s66, s76, 55296
    s_add_u32 s66, s66, s64
    v_mov_b32 v16, 0
    v_mov_b32 v17, 0
    v_mov_b32 v18, 0
    v_mov_b32 v19, 0
    v_mov_b32 v20, 0
    v_mov_b32 v21, 0
    v_mov_b32 v22, 0
    v_mov_b32 v23, 0
    v_mov_b32 v24, 0
    v_mov_b32 v25, 0
    v_mov_b32 v26, 0
    v_mov_b32 v27, 0
    v_mov_b32 v28, 0
    v_mov_b32 v29, 0
    v_mov_b32 v30, 0
    v_mov_b32 v31, 0
    v_mov_b32 v32, 0
    v_mov_b32 v33, 0
    v_mov_b32 v34, 0
    v_mov_b32 v35, 0
    v_mov_b32 v36, 0
    v_mov_b32 v37, 0
    v_mov_b32 v38, 0
    v_mov_b32 v39, 0
    v_mov_b32 v40, 0
    v_mov_b32 v41, 0
    v_mov_b32 v42, 0
    v_mov_b32 v43, 0
    v_mov_b32 v44, 0
    v_mov_b32 v45, 0
    v_mov_b32 v46, 0
    v_mov_b32 v47, 0
    v_mov_b32 v48, 0
    v_mov_b32 v49, 0
    v_mov_b32 v50, 0
    v_mov_b32 v51, 0
    v_mov_b32 v52, 0
    v_mov_b32 v53, 0
    v_mov_b32 v54, 0
    v_mov_b32 v55, 0
    s_mul_i32 s60, s59, 15360
    v_add_u32 v7, s60, v6
    s_mov_b32 s67, 0
    s_branch L_p5_a
p5x_133:
    s_cmp_lg_u32 s54, 6
    s_cbranch_scc1 L_p5_a
    v_mov_b32 v242, 5
    s_mov_b64 exec, 1
    s_cmp_lg_u32 s55, 0
    s_cbranch_scc1 fmix_134
    buffer_store_dword v242, v241, s[36:39], s27 offen
fdone_135:
    s_mov_b64 exec, -1
    s_mov_b32 s92, 0
poll_136:
    buffer_load_dword v243, v240, s[36:39], s3 offen sc1
pollc_138:
    s_waitcnt vmcnt(0)
    v_cmp_gt_u32 vcc, 5, v243
    s_cbranch_vccz polld_137
    s_add_u32 s92, s92, 1
    s_cmp_lt_u32 s92, 0x40000
    s_cbranch_scc1 poll_136
polld_137:
    s_cmp_eq_u32 s55, 0
    s_cbranch_scc1 acq_139
    buffer_inv sc1
    s_waitcnt vmcnt(0)
acq_139:
L_p5_a:
    s_barrier
    s_cmp_ge_u32 s54, 4
    s_cbranch_scc1 L_p5_np
    buffer_load_dwordx4 v[80:83], v6, s[36:39], s65 offen offset:0 sc1
    buffer_load_dwordx4 v[84:87], v6, s[36:39], s66 offen offset:0 sc1
    buffer_load_dwordx4 v[88:91], v6, s[36:39], s65 offen offset:1024 sc1
    buffer_load_dwordx4 v[92:95], v6, s[36:39], s66 offen offset:1024 sc1
    buffer_load_dwordx4 v[96:99], v6, s[36:39], s65 offen offset:2048 sc1
    buffer_load_dwordx4 v[100:103], v6, s[36:39], s66 offen offset:2048 sc1
    s_add_u32 s65, s65, 3072
    s_add_u32 s66, s66, 3072
    buffer_load_dwordx4 v[104:107], v6, s[36:39], s65 offen offset:0 sc1
    buffer_load_dwordx4 v[108:111], v6, s[36:39], s66 offen offset:0 sc1
    buffer_load_dwordx4 v[112:115], v6, s[36:39], s65 offen offset:1024 sc1
    buffer_load_dwordx4 v[116:119], v6, s[36:39], s66 offen offset:1024 sc1
    buffer_load_dwordx4 v[120:123], v6, s[36:39], s65 offen offset:2048 sc1
    buffer_load_dwordx4 v[124:127], v6, s[36:39], s66 offen offset:2048 sc1
    s_add_u32 s65, s65, 3072
    s_add_u32 s66, s66, 3072
    s_barrier
    ds_read_b128 v[160:163], v7 offset:0
    ds_read_b128 v[164:167], v7 offset:1024
    ds_read_b128 v[168:171], v7 offset:2048
    ds_read_b128 v[172:175], v7 offset:3072
    ds_read_b128 v[176:179], v7 offset:4096
    buffer_load_dwordx4 v[128:131], v6, s[36:39], s65 offen offset:0 sc1
    buffer_load_dwordx4 v[132:135], v6, s[36:39], s66 offen offset:0 sc1
    buffer_load_dwordx4 v[136:139], v6, s[36:39], s65 offen offset:1024 sc1
    buffer_load_dwordx4 v[140:143], v6, s[36:39], s66 offen offset:1024 sc1
    buffer_load_dwordx4 v[144:147], v6, s[36:39], s65 offen offset:2048 sc1
    buffer_load_dwordx4 v[148:151], v6, s[36:39], s66 offen offset:2048 sc1
    s_add_u32 s65, s65, 3072
    s_add_u32 s66, s66, 3072
    s_waitcnt vmcnt(12)
    s_waitcnt lgkmcnt(0)
    v_mfma_f32_16x16x32_bf16 v[16:19], v[160:163], v[80:83], v[16:19]
    ds_read_b128 v[180:183], v7 offset:5120
    v_mfma_f32_16x16x32_bf16 v[20:23], v[160:163], v[84:87], v[20:23]
    v_mfma_f32_16x16x32_bf16 v[24:27], v[164:167], v[80:83], v[24:27]
    ds_read_b128 v[184:187], v7 offset:6144
    v_mfma_f32_16x16x32_bf16 v[28:31], v[164:167], v[84:87], v[28:31]
    v_mfma_f32_16x16x32_bf16 v[32:35], v[168:171], v[80:83], v[32:35]
    ds_read_b128 v[188:191], v7 offset:7168
    v_mfma_f32_16x16x32_bf16 v[36:39], v[168:171], v[84:87], v[36:39]
    v_mfma_f32_16x16x32_bf16 v[40:43], v[172:175], v[80:83], v[40:43]
    ds_read_b128 v[192:195], v7 offset:8192
    v_mfma_f32_16x16x32_bf16 v[44:47], v[172:175], v[84:87], v[44:47]
    v_mfma_f32_16x16x32_bf16 v[48:51], v[176:179], v[80:83], v[48:51]
    ds_read_b128 v[196:199], v7 offset:9216
    v_mfma_f32_16x16x32_bf16 v[52:55], v[176:179], v[84:87], v[52:55]
    s_waitcnt lgkmcnt(0)
    v_mfma_f32_16x16x32_bf16 v[16:19], v[180:183], v[88:91], v[16:19]
    ds_read_b128 v[160:163], v7 offset:10240
    v_mfma_f32_16x16x32_bf16 v[20:23], v[180:183], v[92:95], v[20:23]
    v_mfma_f32_16x16x32_bf16 v[24:27], v[184:187], v[88:91], v[24:27]
    ds_read_b128 v[164:167], v7 offset:11264
    v_mfma_f32_16x16x32_bf16 v[28:31], v[184:187], v[92:95], v[28:31]
    v_mfma_f32_16x16x32_bf16 v[32:35], v[188:191], v[88:91], v[32:35]
    ds_read_b128 v[168:171], v7 offset:12288
    v_mfma_f32_16x16x32_bf16 v[36:39], v[188:191], v[92:95], v[36:39]
    v_mfma_f32_16x16x32_bf16 v[40:43], v[192:195], v[88:91], v[40:43]
    ds_read_b128 v[172:175], v7 offset:13312
    v_mfma_f32_16x16x32_bf16 v[44:47], v[192:195], v[92:95], v[44:47]
    v_mfma_f32_16x16x32_bf16 v[48:51], v[196:199], v[88:91], v[48:51]
    ds_read_b128 v[176:179], v7 offset:14336
    v_mfma_f32_16x16x32_bf16 v[52:55], v[196:199], v[92:95], v[52:55]
    s_waitcnt lgkmcnt(0)
    s_add_u32 s67, s67, 1
    s_cmp_eq_u32 s67, 5
    s_mov_b32 s61, 30720
    s_cselect_b32 s61, 0xfffe2000, s61
    s_cselect_b32 s67, 0, s67
    v_add_u32 v7, s61, v7
    v_mfma_f32_16x16x32_bf16 v[16:19], v[160:163], v[96:99], v[16:19]
    ds_read_b128 v[180:183], v7 offset:0
    v_mfma_f32_16x16x32_bf16 v[20:23], v[160:163], v[100:103], v[20:23]
    v_mfma_f32_16x16x32_bf16 v[24:27], v[164:167], v[96:99], v[24:27]
    ds_read_b128 v[184:187], v7 offset:1024
    v_mfma_f32_16x16x32_bf16 v[28:31], v[164:167], v[100:103], v[28:31]
    v_mfma_f32_16x16x32_bf16 v[32:35], v[168:171], v[96:99], v[32:35]
    ds_read_b128 v[188:191], v7 offset:2048
    v_mfma_f32_16x16x32_bf16 v[36:39], v[168:171], v[100:103], v[36:39]
    v_mfma_f32_16x16x32_bf16 v[40:43], v[172:175], v[96:99], v[40:43]
    ds_read_b128 v[192:195], v7 offset:3072
    v_mfma_f32_16x16x32_bf16 v[44:47], v[172:175], v[100:103], v[44:47]
    v_mfma_f32_16x16x32_bf16 v[48:51], v[176:179], v[96:99], v[48:51]
    ds_read_b128 v[196:199], v7 offset:4096
    v_mfma_f32_16x16x32_bf16 v[52:55], v[176:179], v[100:103], v[52:55]
    s_waitcnt lgkmcnt(0)
    s_barrier
    buffer_load_dwordx4 v[80:83], v6, s[36:39], s65 offen offset:0 sc1
    buffer_load_dwordx4 v[84:87], v6, s[36:39], s66 offen offset:0 sc1
    buffer_load_dwordx4 v[88:91], v6, s[36:39], s65 offen offset:1024 sc1
    buffer_load_dwordx4 v[92:95], v6, s[36:39], s66 offen offset:1024 sc1
    buffer_load_dwordx4 v[96:99], v6, s[36:39], s65 offen offset:2048 sc1
    buffer_load_dwordx4 v[100:103], v6, s[36:39], s66 offen offset:2048 sc1
    s_add_u32 s65, s65, 3072
    s_add_u32 s66, s66, 3072
    s_waitcnt vmcnt(12)
    s_waitcnt lgkmcnt(0)
    v_mfma_f32_16x16x32_bf16 v[16:19], v[180:183], v[104:107], v[16:19]
    ds_read_b128 v[160:163], v7 offset:5120
    v_mfma_f32_16x16x32_bf16 v[20:23], v[180:183], v[108:111], v[20:23]
    v_mfma_f32_16x16x32_bf16 v[24:27], v[184:187], v[104:107], v[24:27]
    ds_read_b128 v[164:167], v7 offset:6144
    v_mfma_f32_16x16x32_bf16 v[28:31], v[184:187], v[108:111], v[28:31]
    v_mfma_f32_16x16x32_bf16 v[32:35], v[188:191], v[104:107], v[32:35]
    ds_read_b128 v[168:171], v7 offset:7168
    v_mfma_f32_16x16x32_bf16 v[36:39], v[188:191], v[108:111], v[36:39]
    v_mfma_f32_16x16x32_bf16 v[40:43], v[192:195], v[104:107], v[40:43]
    ds_read_b128 v[172:175], v7 offset:8192
    v_mfma_f32_16x16x32_bf16 v[44:47], v[192:195], v[108:111], v[44:47]
    v_mfma_f32_16x16x32_bf16 v[48:51], v[196:199], v[104:107], v[48:51]
    ds_read_b128 v[176:179], v7 offset:9216
    v_mfma_f32_16x16x32_bf16 v[52:55], v[196:199], v[108:111], v[52:55]
    s_waitcnt lgkmcnt(0)
    v_mfma_f32_16x16x32_bf16 v[16:19], v[160:163], v[112:115], v[16:19]
    ds_read_b128 v[180:183], v7 offset:10240
    v_mfma_f32_16x16x32_bf16 v[20:23], v[160:163], v[116:119], v[20:23]
    v_mfma_f32_16x16x32_bf16 v[24:27], v[164:167], v[112:115], v[24:27]
    ds_read_b128 v[184:187], v7 offset:11264
    v_mfma_f32_16x16x32_bf16 v[28:31], v[164:167], v[116:119], v[28:31]
    v_mfma_f32_16x16x32_bf16 v[32:35], v[168:171], v[112:115], v[32:35]
    ds_read_b128 v[188:191], v7 offset:12288
    v_mfma_f32_16x16x32_bf16 v[36:39], v[168:171], v[116:119], v[36:39]
    v_mfma_f32_16x16x32_bf16 v[40:43], v[172:175], v[112:115], v[40:43]
    ds_read_b128 v[192:195], v7 offset:13312
    v_mfma_f32_16x16x32_bf16 v[44:47], v[172:175], v[116:119], v[44:47]
    v_mfma_f32_16x16x32_bf16 v[48:51], v[176:179], v[112:115], v[48:51]
    ds_read_b128 v[196:199], v7 offset:14336
    v_mfma_f32_16x16x32_bf16 v[52:55], v[176:179], v[116:119], v[52:55]
    s_waitcnt lgkmcnt(0)
    s_add_u32 s67, s67, 1
    s_cmp_eq_u32 s67, 5
    s_mov_b32 s61, 30720
    s_cselect_b32 s61, 0xfffe2000, s61
    s_cselect_b32 s67, 0, s67
    v_add_u32 v7, s61, v7
    v_mfma_f32_16x16x32_bf16 v[16:19], v[180:183], v[120:123], v[16:19]
    ds_read_b128 v[160:163], v7 offset:0
    v_mfma_f32_16x16x32_bf16 v[20:23], v[180:183], v[124:127], v[20:23]
    v_mfma_f32_16x16x32_bf16 v[24:27], v[184:187], v[120:123], v[24:27]
    ds_read_b128 v[164:167], v7 offset:1024
    v_mfma_f32_16x16x32_bf16 v[28:31], v[184:187], v[124:127], v[28:31]
    v_mfma_f32_16x16x32_bf16 v[32:35], v[188:191], v[120:123], v[32:35]
    ds_read_b128 v[168:171], v7 offset:2048
    v_mfma_f32_16x16x32_bf16 v[36:39], v[188:191], v[124:127], v[36:39]
    v_mfma_f32_16x16x32_bf16 v[40:43], v[192:195], v[120:123], v[40:43]
    ds_read_b128 v[172:175], v7 offset:3072
    v_mfma_f32_16x16x32_bf16 v[44:47], v[192:195], v[124:127], v[44:47]
    v_mfma_f32_16x16x32_bf16 v[48:51], v[196:199], v[120:123], v[48:51]
    ds_read_b128 v[176:179], v7 offset:4096
    v_mfma_f32_16x16x32_bf16 v[52:55], v[196:199], v[124:127], v[52:55]
    s_waitcnt lgkmcnt(0)
    s_barrier
    buffer_load_dwordx4 v[104:107], v6, s[36:39], s65 offen offset:0 sc1
    buffer_load_dwordx4 v[108:111], v6, s[36:39], s66 offen offset:0 sc1
    buffer_load_dwordx4 v[112:115], v6, s[36:39], s65 offen offset:1024 sc1
    buffer_load_dwordx4 v[116:119], v6, s[36:39], s66 offen offset:1024 sc1
    buffer_load_dwordx4 v[120:123], v6, s[36:39], s65 offen offset:2048 sc1
    buffer_load_dwordx4 v[124:127], v6, s[36:39], s66 offen offset:2048 sc1
    s_add_u32 s65, s65, 3072
    s_add_u32 s66, s66, 3072
    s_waitcnt vmcnt(12)
    s_waitcnt lgkmcnt(0)
    v_mfma_f32_16x16x32_bf16 v[16:19], v[160:163], v[128:131], v[16:19]
    ds_read_b128 v[180:183], v7 offset:5120
    v_mfma_f32_16x16x32_bf16 v[20:23], v[160:163], v[132:135], v[20:23]
    v_mfma_f32_16x16x32_bf16 v[24:27], v[164:167], v[128:131], v[24:27]
    ds_read_b128 v[184:187], v7 offset:6144
    v_mfma_f32_16x16x32_bf16 v[28:31], v[164:167], v[132:135], v[28:31]
    v_mfma_f32_16x16x32_bf16 v[32:35], v[168:171], v[128:131], v[32:35]
    ds_read_b128 v[188:191], v7 offset:7168
    v_mfma_f32_16x16x32_bf16 v[36:39], v[168:171], v[132:135], v[36:39]
    v_mfma_f32_16x16x32_bf16 v[40:43], v[172:175], v[128:131], v[40:43]
    ds_read_b128 v[192:195], v7 offset:8192
    v_mfma_f32_16x16x32_bf16 v[44:47], v[172:175], v[132:135], v[44:47]
    v_mfma_f32_16x16x32_bf16 v[48:51], v[176:179], v[128:131], v[48:51]
    ds_read_b128 v[196:199], v7 offset:9216
    v_mfma_f32_16x16x32_bf16 v[52:55], v[176:179], v[132:135], v[52:55]
    s_waitcnt lgkmcnt(0)
    v_mfma_f32_16x16x32_bf16 v[16:19], v[180:183], v[136:139], v[16:19]
    ds_read_b128 v[160:163], v7 offset:10240
    v_mfma_f32_16x16x32_bf16 v[20:23], v[180:183], v[140:143], v[20:23]
    v_mfma_f32_16x16x32_bf16 v[24:27], v[184:187], v[136:139], v[24:27]
    ds_read_b128 v[164:167], v7 offset:11264
    v_mfma_f32_16x16x32_bf16 v[28:31], v[184:187], v[140:143], v[28:31]
    v_mfma_f32_16x16x32_bf16 v[32:35], v[188:191], v[136:139], v[32:35]
    ds_read_b128 v[168:171], v7 offset:12288
    v_mfma_f32_16x16x32_bf16 v[36:39], v[188:191], v[140:143], v[36:39]
    v_mfma_f32_16x16x32_bf16 v[40:43], v[192:195], v[136:139], v[40:43]
    ds_read_b128 v[172:175], v7 offset:13312
    v_mfma_f32_16x16x32_bf16 v[44:47], v[192:195], v[140:143], v[44:47]
    v_mfma_f32_16x16x32_bf16 v[48:51], v[196:199], v[136:139], v[48:51]
    ds_read_b128 v[176:179], v7 offset:14336
    v_mfma_f32_16x16x32_bf16 v[52:55], v[196:199], v[140:143], v[52:55]
    s_waitcnt lgkmcnt(0)
    s_add_u32 s67, s67, 1
    s_cmp_eq_u32 s67, 5
    s_mov_b32 s61, 30720
    s_cselect_b32 s61, 0xfffe2000, s61
    s_cselect_b32 s67, 0, s67
    v_add_u32 v7, s61, v7
    v_mfma_f32_16x16x32_bf16 v[16:19], v[160:163], v[144:147], v[16:19]
    ds_read_b128 v[180:183], v7 offset:0
    v_mfma_f32_16x16x32_bf16 v[20:23], v[160:163], v[148:151], v[20:23]
    v_mfma_f32_16x16x32_bf16 v[24:27], v[164:167], v[144:147], v[24:27]
    ds_read_b128 v[184:187], v7 offset:1024
    v_mfma_f32_16x16x32_bf16 v[28:31], v[164:167], v[148:151], v[28:31]
    v_mfma_f32_16x16x32_bf16 v[32:35], v[168:171], v[144:147], v[32:35]
    ds_read_b128 v[188:191], v7 offset:2048
    v_mfma_f32_16x16x32_bf16 v[36:39], v[168:171], v[148:151], v[36:39]
    v_mfma_f32_16x16x32_bf16 v[40:43], v[172:175], v[144:147], v[40:43]
    ds_read_b128 v[192:195], v7 offset:3072
    v_mfma_f32_16x16x32_bf16 v[44:47], v[172:175], v[148:151], v[44:47]
    v_mfma_f32_16x16x32_bf16 v[48:51], v[176:179], v[144:147], v[48:51]
    ds_read_b128 v[196:199], v7 offset:4096
    v_mfma_f32_16x16x32_bf16 v[52:55], v[176:179], v[148:151], v[52:55]
    s_waitcnt lgkmcnt(0)
    s_barrier
    buffer_load_dwordx4 v[128:131], v6, s[36:39], s65 offen offset:0 sc1
    buffer_load_dwordx4 v[132:135], v6, s[36:39], s66 offen offset:0 sc1
    buffer_load_dwordx4 v[136:139], v6, s[36:39], s65 offen offset:1024 sc1
    buffer_load_dwordx4 v[140:143], v6, s[36:39], s66 offen offset:1024 sc1
    buffer_load_dwordx4 v[144:147], v6, s[36:39], s65 offen offset:2048 sc1
    buffer_load_dwordx4 v[148:151], v6, s[36:39], s66 offen offset:2048 sc1
    s_add_u32 s65, s65, 3072
    s_add_u32 s66, s66, 3072
    s_waitcnt vmcnt(12)
    s_waitcnt lgkmcnt(0)
    v_mfma_f32_16x16x32_bf16 v[16:19], v[180:183], v[80:83], v[16:19]
    ds_read_b128 v[160:163], v7 offset:5120
    v_mfma_f32_16x16x32_bf16 v[20:23], v[180:183], v[84:87], v[20:23]
    v_mfma_f32_16x16x32_bf16 v[24:27], v[184:187], v[80:83], v[24:27]
    ds_read_b128 v[164:167], v7 offset:6144
    v_mfma_f32_16x16x32_bf16 v[28:31], v[184:187], v[84:87], v[28:31]
    v_mfma_f32_16x16x32_bf16 v[32:35], v[188:191], v[80:83], v[32:35]
    ds_read_b128 v[168:171], v7 offset:7168
    v_mfma_f32_16x16x32_bf16 v[36:39], v[188:191], v[84:87], v[36:39]
    v_mfma_f32_16x16x32_bf16 v[40:43], v[192:195], v[80:83], v[40:43]
    ds_read_b128 v[172:175], v7 offset:8192
    v_mfma_f32_16x16x32_bf16 v[44:47], v[192:195], v[84:87], v[44:47]
    v_mfma_f32_16x16x32_bf16 v[48:51], v[196:199], v[80:83], v[48:51]
    ds_read_b128 v[176:179], v7 offset:9216
    v_mfma_f32_16x16x32_bf16 v[52:55], v[196:199], v[84:87], v[52:55]
    s_waitcnt lgkmcnt(0)
    v_mfma_f32_16x16x32_bf16 v[16:19], v[160:163], v[88:91], v[16:19]
    ds_read_b128 v[180:183], v7 offset:10240
    v_mfma_f32_16x16x32_bf16 v[20:23], v[160:163], v[92:95], v[20:23]
    v_mfma_f32_16x16x32_bf16 v[24:27], v[164:167], v[88:91], v[24:27]
    ds_read_b128 v[184:187], v7 offset:11264
    v_mfma_f32_16x16x32_bf16 v[28:31], v[164:167], v[92:95], v[28:31]
    v_mfma_f32_16x16x32_bf16 v[32:35], v[168:171], v[88:91], v[32:35]
    ds_read_b128 v[188:191], v7 offset:12288
    v_mfma_f32_16x16x32_bf16 v[36:39], v[168:171], v[92:95], v[36:39]
    v_mfma_f32_16x16x32_bf16 v[40:43], v[172:175], v[88:91], v[40:43]
    ds_read_b128 v[192:195], v7 offset:13312
    v_mfma_f32_16x16x32_bf16 v[44:47], v[172:175], v[92:95], v[44:47]
    v_mfma_f32_16x16x32_bf16 v[48:51], v[176:179], v[88:91], v[48:51]
    ds_read_b128 v[196:199], v7 offset:14336
    v_mfma_f32_16x16x32_bf16 v[52:55], v[176:179], v[92:95], v[52:55]
    s_waitcnt lgkmcnt(0)
    s_add_u32 s67, s67, 1
    s_cmp_eq_u32 s67, 5
    s_mov_b32 s61, 30720
    s_cselect_b32 s61, 0xfffe2000, s61
    s_cselect_b32 s67, 0, s67
    v_add_u32 v7, s61, v7
    v_mfma_f32_16x16x32_bf16 v[16:19], v[180:183], v[96:99], v[16:19]
    ds_read_b128 v[160:163], v7 offset:0
    v_mfma_f32_16x16x32_bf16 v[20:23], v[180:183], v[100:103], v[20:23]
    v_mfma_f32_16x16x32_bf16 v[24:27], v[184:187], v[96:99], v[24:27]
    ds_read_b128 v[164:167], v7 offset:1024
    v_mfma_f32_16x16x32_bf16 v[28:31], v[184:187], v[100:103], v[28:31]
    v_mfma_f32_16x16x32_bf16 v[32:35], v[188:191], v[96:99], v[32:35]
    ds_read_b128 v[168:171], v7 offset:2048
    v_mfma_f32_16x16x32_bf16 v[36:39], v[188:191], v[100:103], v[36:39]
    v_mfma_f32_16x16x32_bf16 v[40:43], v[192:195], v[96:99], v[40:43]
    ds_read_b128 v[172:175], v7 offset:3072
    v_mfma_f32_16x16x32_bf16 v[44:47], v[192:195], v[100:103], v[44:47]
    v_mfma_f32_16x16x32_bf16 v[48:51], v[196:199], v[96:99], v[48:51]
    ds_read_b128 v[176:179], v7 offset:4096
    v_mfma_f32_16x16x32_bf16 v[52:55], v[196:199], v[100:103], v[52:55]
    s_waitcnt lgkmcnt(0)
    s_barrier
    buffer_load_dwordx4 v[80:83], v6, s[36:39], s65 offen offset:0 sc1
    buffer_load_dwordx4 v[84:87], v6, s[36:39], s66 offen offset:0 sc1
    buffer_load_dwordx4 v[88:91], v6, s[36:39], s65 offen offset:1024 sc1
    buffer_load_dwordx4 v[92:95], v6, s[36:39], s66 offen offset:1024 sc1
    buffer_load_dwordx4 v[96:99], v6, s[36:39], s65 offen offset:2048 sc1
    buffer_load_dwordx4 v[100:103], v6, s[36:39], s66 offen offset:2048 sc1
    s_add_u32 s65, s65, 3072
    s_add_u32 s66, s66, 3072
    s_waitcnt vmcnt(12)
    s_waitcnt lgkmcnt(0)
    v_mfma_f32_16x16x32_bf16 v[16:19], v[160:163], v[104:107], v[16:19]
    ds_read_b128 v[180:183], v7 offset:5120
    v_mfma_f32_16x16x32_bf16 v[20:23], v[160:163], v[108:111], v[20:23]
    v_mfma_f32_16x16x32_bf16 v[24:27], v[164:167], v[104:107], v[24:27]
    ds_read_b128 v[184:187], v7 offset:6144
    v_mfma_f32_16x16x32_bf16 v[28:31], v[164:167], v[108:111], v[28:31]
    v_mfma_f32_16x16x32_bf16 v[32:35], v[168:171], v[104:107], v[32:35]
    ds_read_b128 v[188:191], v7 offset:7168
    v_mfma_f32_16x16x32_bf16 v[36:39], v[168:171], v[108:111], v[36:39]
    v_mfma_f32_16x16x32_bf16 v[40:43], v[172:175], v[104:107], v[40:43]
    ds_read_b128 v[192:195], v7 offset:8192
    v_mfma_f32_16x16x32_bf16 v[44:47], v[172:175], v[108:111], v[44:47]
    v_mfma_f32_16x16x32_bf16 v[48:51], v[176:179], v[104:107], v[48:51]
    ds_read_b128 v[196:199], v7 offset:9216
    v_mfma_f32_16x16x32_bf16 v[52:55], v[176:179], v[108:111], v[52:55]
    s_waitcnt lgkmcnt(0)
    v_mfma_f32_16x16x32_bf16 v[16:19], v[180:183], v[112:115], v[16:19]
    ds_read_b128 v[160:163], v7 offset:10240
    v_mfma_f32_16x16x32_bf16 v[20:23], v[180:183], v[116:119], v[20:23]
    v_mfma_f32_16x16x32_bf16 v[24:27], v[184:187], v[112:115], v[24:27]
    ds_read_b128 v[164:167], v7 offset:11264
    v_mfma_f32_16x16x32_bf16 v[28:31], v[184:187], v[116:119], v[28:31]
    v_mfma_f32_16x16x32_bf16 v[32:35], v[188:191], v[112:115], v[32:35]
    ds_read_b128 v[168:171], v7 offset:12288
    v_mfma_f32_16x16x32_bf16 v[36:39], v[188:191], v[116:119], v[36:39]
    v_mfma_f32_16x16x32_bf16 v[40:43], v[192:195], v[112:115], v[40:43]
    ds_read_b128 v[172:175], v7 offset:13312
    v_mfma_f32_16x16x32_bf16 v[44:47], v[192:195], v[116:119], v[44:47]
    v_mfma_f32_16x16x32_bf16 v[48:51], v[196:199], v[112:115], v[48:51]
    ds_read_b128 v[176:179], v7 offset:14336
    v_mfma_f32_16x16x32_bf16 v[52:55], v[196:199], v[116:119], v[52:55]
    s_waitcnt lgkmcnt(0)
    s_add_u32 s67, s67, 1
    s_cmp_eq_u32 s67, 5
    s_mov_b32 s61, 30720
    s_cselect_b32 s61, 0xfffe2000, s61
    s_cselect_b32 s67, 0, s67
    v_add_u32 v7, s61, v7
    v_mfma_f32_16x16x32_bf16 v[16:19], v[160:163], v[120:123], v[16:19]
    ds_read_b128 v[180:183], v7 offset:0
    v_mfma_f32_16x16x32_bf16 v[20:23], v[160:163], v[124:127], v[20:23]
    v_mfma_f32_16x16x32_bf16 v[24:27], v[164:167], v[120:123], v[24:27]
    ds_read_b128 v[184:187], v7 offset:1024
    v_mfma_f32_16x16x32_bf16 v[28:31], v[164:167], v[124:127], v[28:31]
    v_mfma_f32_16x16x32_bf16 v[32:35], v[168:171], v[120:123], v[32:35]
    ds_read_b128 v[188:191], v7 offset:2048
    v_mfma_f32_16x16x32_bf16 v[36:39], v[168:171], v[124:127], v[36:39]
    v_mfma_f32_16x16x32_bf16 v[40:43], v[172:175], v[120:123], v[40:43]
    ds_read_b128 v[192:195], v7 offset:3072
    v_mfma_f32_16x16x32_bf16 v[44:47], v[172:175], v[124:127], v[44:47]
    v_mfma_f32_16x16x32_bf16 v[48:51], v[176:179], v[120:123], v[48:51]
    ds_read_b128 v[196:199], v7 offset:4096
    v_mfma_f32_16x16x32_bf16 v[52:55], v[176:179], v[124:127], v[52:55]
    s_waitcnt lgkmcnt(0)
    s_barrier
    buffer_load_dwordx4 v[104:107], v6, s[36:39], s65 offen offset:0 sc1
    buffer_load_dwordx4 v[108:111], v6, s[36:39], s66 offen offset:0 sc1
    buffer_load_dwordx4 v[112:115], v6, s[36:39], s65 offen offset:1024 sc1
    buffer_load_dwordx4 v[116:119], v6, s[36:39], s66 offen offset:1024 sc1
    buffer_load_dwordx4 v[120:123], v6, s[36:39], s65 offen offset:2048 sc1
    buffer_load_dwordx4 v[124:127], v6, s[36:39], s66 offen offset:2048 sc1
    s_add_u32 s65, s65, 3072
    s_add_u32 s66, s66, 3072
    s_waitcnt vmcnt(12)
    s_waitcnt lgkmcnt(0)
    v_mfma_f32_16x16x32_bf16 v[16:19], v[180:183], v[128:131], v[16:19]
    ds_read_b128 v[160:163], v7 offset:5120
    v_mfma_f32_16x16x32_bf16 v[20:23], v[180:183], v[132:135], v[20:23]
    v_mfma_f32_16x16x32_bf16 v[24:27], v[184:187], v[128:131], v[24:27]
    ds_read_b128 v[164:167], v7 offset:6144
    v_mfma_f32_16x16x32_bf16 v[28:31], v[184:187], v[132:135], v[28:31]
    v_mfma_f32_16x16x32_bf16 v[32:35], v[188:191], v[128:131], v[32:35]
    ds_read_b128 v[168:171], v7 offset:7168
    v_mfma_f32_16x16x32_bf16 v[36:39], v[188:191], v[132:135], v[36:39]
    v_mfma_f32_16x16x32_bf16 v[40:43], v[192:195], v[128:131], v[40:43]
    ds_read_b128 v[172:175], v7 offset:8192
    v_mfma_f32_16x16x32_bf16 v[44:47], v[192:195], v[132:135], v[44:47]
    v_mfma_f32_16x16x32_bf16 v[48:51], v[196:199], v[128:131], v[48:51]
    ds_read_b128 v[176:179], v7 offset:9216
    v_mfma_f32_16x16x32_bf16 v[52:55], v[196:199], v[132:135], v[52:55]
    s_waitcnt lgkmcnt(0)
    v_mfma_f32_16x16x32_bf16 v[16:19], v[160:163], v[136:139], v[16:19]
    ds_read_b128 v[180:183], v7 offset:10240
    v_mfma_f32_16x16x32_bf16 v[20:23], v[160:163], v[140:143], v[20:23]
    v_mfma_f32_16x16x32_bf16 v[24:27], v[164:167], v[136:139], v[24:27]
    ds_read_b128 v[184:187], v7 offset:11264
    v_mfma_f32_16x16x32_bf16 v[28:31], v[164:167], v[140:143], v[28:31]
    v_mfma_f32_16x16x32_bf16 v[32:35], v[168:171], v[136:139], v[32:35]
    ds_read_b128 v[188:191], v7 offset:12288
    v_mfma_f32_16x16x32_bf16 v[36:39], v[168:171], v[140:143], v[36:39]
    v_mfma_f32_16x16x32_bf16 v[40:43], v[172:175], v[136:139], v[40:43]
    ds_read_b128 v[192:195], v7 offset:13312
    v_mfma_f32_16x16x32_bf16 v[44:47], v[172:175], v[140:143], v[44:47]
    v_mfma_f32_16x16x32_bf16 v[48:51], v[176:179], v[136:139], v[48:51]
    ds_read_b128 v[196:199], v7 offset:14336
    v_mfma_f32_16x16x32_bf16 v[52:55], v[176:179], v[140:143], v[52:55]
    s_waitcnt lgkmcnt(0)
    s_add_u32 s67, s67, 1
    s_cmp_eq_u32 s67, 5
    s_mov_b32 s61, 30720
    s_cselect_b32 s61, 0xfffe2000, s61
    s_cselect_b32 s67, 0, s67
    v_add_u32 v7, s61, v7
    v_mfma_f32_16x16x32_bf16 v[16:19], v[180:183], v[144:147], v[16:19]
    ds_read_b128 v[160:163], v7 offset:0
    v_mfma_f32_16x16x32_bf16 v[20:23], v[180:183], v[148:151], v[20:23]
    v_mfma_f32_16x16x32_bf16 v[24:27], v[184:187], v[144:147], v[24:27]
    ds_read_b128 v[164:167], v7 offset:1024
    v_mfma_f32_16x16x32_bf16 v[28:31], v[184:187], v[148:151], v[28:31]
    v_mfma_f32_16x16x32_bf16 v[32:35], v[188:191], v[144:147], v[32:35]
    ds_read_b128 v[168:171], v7 offset:2048
    v_mfma_f32_16x16x32_bf16 v[36:39], v[188:191], v[148:151], v[36:39]
    v_mfma_f32_16x16x32_bf16 v[40:43], v[192:195], v[144:147], v[40:43]
    ds_read_b128 v[172:175], v7 offset:3072
    v_mfma_f32_16x16x32_bf16 v[44:47], v[192:195], v[148:151], v[44:47]
    v_mfma_f32_16x16x32_bf16 v[48:51], v[196:199], v[144:147], v[48:51]
    ds_read_b128 v[176:179], v7 offset:4096
    v_mfma_f32_16x16x32_bf16 v[52:55], v[196:199], v[148:151], v[52:55]
    s_waitcnt lgkmcnt(0)
    s_barrier
    buffer_load_dwordx4 v[128:131], v6, s[36:39], s65 offen offset:0 sc1
    buffer_load_dwordx4 v[132:135], v6, s[36:39], s66 offen offset:0 sc1
    buffer_load_dwordx4 v[136:139], v6, s[36:39], s65 offen offset:1024 sc1
    buffer_load_dwordx4 v[140:143], v6, s[36:39], s66 offen offset:1024 sc1
    buffer_load_dwordx4 v[144:147], v6, s[36:39], s65 offen offset:2048 sc1
    buffer_load_dwordx4 v[148:151], v6, s[36:39], s66 offen offset:2048 sc1
    s_add_u32 s65, s65, 3072
    s_add_u32 s66, s66, 3072
    s_waitcnt vmcnt(12)
    s_waitcnt lgkmcnt(0)
    v_mfma_f32_16x16x32_bf16 v[16:19], v[160:163], v[80:83], v[16:19]
    ds_read_b128 v[180:183], v7 offset:5120
    v_mfma_f32_16x16x32_bf16 v[20:23], v[160:163], v[84:87], v[20:23]
    v_mfma_f32_16x16x32_bf16 v[24:27], v[164:167], v[80:83], v[24:27]
    ds_read_b128 v[184:187], v7 offset:6144
    v_mfma_f32_16x16x32_bf16 v[28:31], v[164:167], v[84:87], v[28:31]
    v_mfma_f32_16x16x32_bf16 v[32:35], v[168:171], v[80:83], v[32:35]
    ds_read_b128 v[188:191], v7 offset:7168
    v_mfma_f32_16x16x32_bf16 v[36:39], v[168:171], v[84:87], v[36:39]
    v_mfma_f32_16x16x32_bf16 v[40:43], v[172:175], v[80:83], v[40:43]
    ds_read_b128 v[192:195], v7 offset:8192
    v_mfma_f32_16x16x32_bf16 v[44:47], v[172:175], v[84:87], v[44:47]
    v_mfma_f32_16x16x32_bf16 v[48:51], v[176:179], v[80:83], v[48:51]
    ds_read_b128 v[196:199], v7 offset:9216
    v_mfma_f32_16x16x32_bf16 v[52:55], v[176:179], v[84:87], v[52:55]
    s_waitcnt lgkmcnt(0)
    v_mfma_f32_16x16x32_bf16 v[16:19], v[180:183], v[88:91], v[16:19]
    ds_read_b128 v[160:163], v7 offset:10240
    v_mfma_f32_16x16x32_bf16 v[20:23], v[180:183], v[92:95], v[20:23]
    v_mfma_f32_16x16x32_bf16 v[24:27], v[184:187], v[88:91], v[24:27]
    ds_read_b128 v[164:167], v7 offset:11264
    v_mfma_f32_16x16x32_bf16 v[28:31], v[184:187], v[92:95], v[28:31]
    v_mfma_f32_16x16x32_bf16 v[32:35], v[188:191], v[88:91], v[32:35]
    ds_read_b128 v[168:171], v7 offset:12288
    v_mfma_f32_16x16x32_bf16 v[36:39], v[188:191], v[92:95], v[36:39]
    v_mfma_f32_16x16x32_bf16 v[40:43], v[192:195], v[88:91], v[40:43]
    ds_read_b128 v[172:175], v7 offset:13312
    v_mfma_f32_16x16x32_bf16 v[44:47], v[192:195], v[92:95], v[44:47]
    v_mfma_f32_16x16x32_bf16 v[48:51], v[196:199], v[88:91], v[48:51]
    ds_read_b128 v[176:179], v7 offset:14336
    v_mfma_f32_16x16x32_bf16 v[52:55], v[196:199], v[92:95], v[52:55]
    s_waitcnt lgkmcnt(0)
    s_add_u32 s67, s67, 1
    s_cmp_eq_u32 s67, 5
    s_mov_b32 s61, 30720
    s_cselect_b32 s61, 0xfffe2000, s61
    s_cselect_b32 s67, 0, s67
    v_add_u32 v7, s61, v7
    v_mfma_f32_16x16x32_bf16 v[16:19], v[160:163], v[96:99], v[16:19]
    ds_read_b128 v[180:183], v7 offset:0
    v_mfma_f32_16x16x32_bf16 v[20:23], v[160:163], v[100:103], v[20:23]
    v_mfma_f32_16x16x32_bf16 v[24:27], v[164:167], v[96:99], v[24:27]
    ds_read_b128 v[184:187], v7 offset:1024
    v_mfma_f32_16x16x32_bf16 v[28:31], v[164:167], v[100:103], v[28:31]
    v_mfma_f32_16x16x32_bf16 v[32:35], v[168:171], v[96:99], v[32:35]
    ds_read_b128 v[188:191], v7 offset:2048
    v_mfma_f32_16x16x32_bf16 v[36:39], v[168:171], v[100:103], v[36:39]
    v_mfma_f32_16x16x32_bf16 v[40:43], v[172:175], v[96:99], v[40:43]
    ds_read_b128 v[192:195], v7 offset:3072
    v_mfma_f32_16x16x32_bf16 v[44:47], v[172:175], v[100:103], v[44:47]
    v_mfma_f32_16x16x32_bf16 v[48:51], v[176:179], v[96:99], v[48:51]
    ds_read_b128 v[196:199], v7 offset:4096
    v_mfma_f32_16x16x32_bf16 v[52:55], v[176:179], v[100:103], v[52:55]
    s_waitcnt lgkmcnt(0)
    s_barrier
    s_waitcnt vmcnt(6)
    s_waitcnt lgkmcnt(0)
    v_mfma_f32_16x16x32_bf16 v[16:19], v[180:183], v[104:107], v[16:19]
    ds_read_b128 v[160:163], v7 offset:5120
    v_mfma_f32_16x16x32_bf16 v[20:23], v[180:183], v[108:111], v[20:23]
    v_mfma_f32_16x16x32_bf16 v[24:27], v[184:187], v[104:107], v[24:27]
    ds_read_b128 v[164:167], v7 offset:6144
    v_mfma_f32_16x16x32_bf16 v[28:31], v[184:187], v[108:111], v[28:31]
    v_mfma_f32_16x16x32_bf16 v[32:35], v[188:191], v[104:107], v[32:35]
    ds_read_b128 v[168:171], v7 offset:7168
    v_mfma_f32_16x16x32_bf16 v[36:39], v[188:191], v[108:111], v[36:39]
    v_mfma_f32_16x16x32_bf16 v[40:43], v[192:195], v[104:107], v[40:43]
    ds_read_b128 v[172:175], v7 offset:8192
    v_mfma_f32_16x16x32_bf16 v[44:47], v[192:195], v[108:111], v[44:47]
    v_mfma_f32_16x16x32_bf16 v[48:51], v[196:199], v[104:107], v[48:51]
    ds_read_b128 v[176:179], v7 offset:9216
    v_mfma_f32_16x16x32_bf16 v[52:55], v[196:199], v[108:111], v[52:55]
    s_waitcnt lgkmcnt(0)
    v_mfma_f32_16x16x32_bf16 v[16:19], v[160:163], v[112:115], v[16:19]
    ds_read_b128 v[180:183], v7 offset:10240
    v_mfma_f32_16x16x32_bf16 v[20:23], v[160:163], v[116:119], v[20:23]
    v_mfma_f32_16x16x32_bf16 v[24:27], v[164:167], v[112:115], v[24:27]
    ds_read_b128 v[184:187], v7 offset:11264
    v_mfma_f32_16x16x32_bf16 v[28:31], v[164:167], v[116:119], v[28:31]
    v_mfma_f32_16x16x32_bf16 v[32:35], v[168:171], v[112:115], v[32:35]
    ds_read_b128 v[188:191], v7 offset:12288
    v_mfma_f32_16x16x32_bf16 v[36:39], v[168:171], v[116:119], v[36:39]
    v_mfma_f32_16x16x32_bf16 v[40:43], v[172:175], v[112:115], v[40:43]
    ds_read_b128 v[192:195], v7 offset:13312
    v_mfma_f32_16x16x32_bf16 v[44:47], v[172:175], v[116:119], v[44:47]
    v_mfma_f32_16x16x32_bf16 v[48:51], v[176:179], v[112:115], v[48:51]
    ds_read_b128 v[196:199], v7 offset:14336
    v_mfma_f32_16x16x32_bf16 v[52:55], v[176:179], v[116:119], v[52:55]
    s_waitcnt lgkmcnt(0)
    s_add_u32 s67, s67, 1
    s_cmp_eq_u32 s67, 5
    s_mov_b32 s61, 30720
    s_cselect_b32 s61, 0xfffe2000, s61
    s_cselect_b32 s67, 0, s67
    v_add_u32 v7, s61, v7
    v_mfma_f32_16x16x32_bf16 v[16:19], v[180:183], v[120:123], v[16:19]
    ds_read_b128 v[160:163], v7 offset:0
    v_mfma_f32_16x16x32_bf16 v[20:23], v[180:183], v[124:127], v[20:23]
    v_mfma_f32_16x16x32_bf16 v[24:27], v[184:187], v[120:123], v[24:27]
    ds_read_b128 v[164:167], v7 offset:1024
    v_mfma_f32_16x16x32_bf16 v[28:31], v[184:187], v[124:127], v[28:31]
    v_mfma_f32_16x16x32_bf16 v[32:35], v[188:191], v[120:123], v[32:35]
    ds_read_b128 v[168:171], v7 offset:2048
    v_mfma_f32_16x16x32_bf16 v[36:39], v[188:191], v[124:127], v[36:39]
    v_mfma_f32_16x16x32_bf16 v[40:43], v[192:195], v[120:123], v[40:43]
    ds_read_b128 v[172:175], v7 offset:3072
    v_mfma_f32_16x16x32_bf16 v[44:47], v[192:195], v[124:127], v[44:47]
    v_mfma_f32_16x16x32_bf16 v[48:51], v[196:199], v[120:123], v[48:51]
    ds_read_b128 v[176:179], v7 offset:4096
    v_mfma_f32_16x16x32_bf16 v[52:55], v[196:199], v[124:127], v[52:55]
    s_waitcnt lgkmcnt(0)
    s_barrier
    s_waitcnt vmcnt(0)
    s_waitcnt lgkmcnt(0)
    v_mfma_f32_16x16x32_bf16 v[16:19], v[160:163], v[128:131], v[16:19]
    ds_read_b128 v[180:183], v7 offset:5120
    v_mfma_f32_16x16x32_bf16 v[20:23], v[160:163], v[132:135], v[20:23]
    v_mfma_f32_16x16x32_bf16 v[24:27], v[164:167], v[128:131], v[24:27]
    ds_read_b128 v[184:187], v7 offset:6144
    v_mfma_f32_16x16x32_bf16 v[28:31], v[164:167], v[132:135], v[28:31]
    v_mfma_f32_16x16x32_bf16 v[32:35], v[168:171], v[128:131], v[32:35]
    ds_read_b128 v[188:191], v7 offset:7168
    v_mfma_f32_16x16x32_bf16 v[36:39], v[168:171], v[132:135], v[36:39]
    v_mfma_f32_16x16x32_bf16 v[40:43], v[172:175], v[128:131], v[40:43]
    ds_read_b128 v[192:195], v7 offset:8192
    v_mfma_f32_16x16x32_bf16 v[44:47], v[172:175], v[132:135], v[44:47]
    v_mfma_f32_16x16x32_bf16 v[48:51], v[176:179], v[128:131], v[48:51]
    ds_read_b128 v[196:199], v7 offset:9216
    v_mfma_f32_16x16x32_bf16 v[52:55], v[176:179], v[132:135], v[52:55]
    s_waitcnt lgkmcnt(0)
    v_mfma_f32_16x16x32_bf16 v[16:19], v[180:183], v[136:139], v[16:19]
    ds_read_b128 v[160:163], v7 offset:10240
    v_mfma_f32_16x16x32_bf16 v[20:23], v[180:183], v[140:143], v[20:23]
    v_mfma_f32_16x16x32_bf16 v[24:27], v[184:187], v[136:139], v[24:27]
    ds_read_b128 v[164:167], v7 offset:11264
    v_mfma_f32_16x16x32_bf16 v[28:31], v[184:187], v[140:143], v[28:31]
    v_mfma_f32_16x16x32_bf16 v[32:35], v[188:191], v[136:139], v[32:35]
    ds_read_b128 v[168:171], v7 offset:12288
    v_mfma_f32_16x16x32_bf16 v[36:39], v[188:191], v[140:143], v[36:39]
    v_mfma_f32_16x16x32_bf16 v[40:43], v[192:195], v[136:139], v[40:43]
    ds_read_b128 v[172:175], v7 offset:13312
    v_mfma_f32_16x16x32_bf16 v[44:47], v[192:195], v[140:143], v[44:47]
    v_mfma_f32_16x16x32_bf16 v[48:51], v[196:199], v[136:139], v[48:51]
    ds_read_b128 v[176:179], v7 offset:14336
    v_mfma_f32_16x16x32_bf16 v[52:55], v[196:199], v[140:143], v[52:55]
    s_waitcnt lgkmcnt(0)
    v_mfma_f32_16x16x32_bf16 v[16:19], v[160:163], v[144:147], v[16:19]
    v_mfma_f32_16x16x32_bf16 v[20:23], v[160:163], v[148:151], v[20:23]
    v_mfma_f32_16x16x32_bf16 v[24:27], v[164:167], v[144:147], v[24:27]
    v_mfma_f32_16x16x32_bf16 v[28:31], v[164:167], v[148:151], v[28:31]
    v_mfma_f32_16x16x32_bf16 v[32:35], v[168:171], v[144:147], v[32:35]
    v_mfma_f32_16x16x32_bf16 v[36:39], v[168:171], v[148:151], v[36:39]
    v_mfma_f32_16x16x32_bf16 v[40:43], v[172:175], v[144:147], v[40:43]
    v_mfma_f32_16x16x32_bf16 v[44:47], v[172:175], v[148:151], v[44:47]
    v_mfma_f32_16x16x32_bf16 v[48:51], v[176:179], v[144:147], v[48:51]
    v_mfma_f32_16x16x32_bf16 v[52:55], v[176:179], v[148:151], v[52:55]
    s_barrier
    s_nop 7
    v_lshlrev_b32 v3, 4, v2
    s_mul_i32 s60, s54, 5120
    s_add_u32 s60, s60, 0
    v_add_u32 v4, s60, v3
    ds_write_b128 v4, v[20:23] offset:0
    ds_write_b128 v4, v[28:31] offset:1024
    ds_write_b128 v4, v[36:39] offset:2048
    ds_write_b128 v4, v[44:47] offset:3072
    ds_write_b128 v4, v[52:55] offset:4096
    s_waitcnt lgkmcnt(0)
    s_barrier
    s_xor_b32 s60, s54, 2
    s_mul_i32 s60, s60, 5120
    s_add_u32 s60, s60, 0
    v_add_u32 v4, s60, v3
    ds_read_b128 v[20:23], v4 offset:0
    ds_read_b128 v[28:31], v4 offset:1024
    ds_read_b128 v[36:39], v4 offset:2048
    ds_read_b128 v[44:47], v4 offset:3072
    ds_read_b128 v[52:55], v4 offset:4096
    s_waitcnt lgkmcnt(0)
    v_add_f32 v16, v16, v20
    v_add_f32 v17, v17, v21
    v_add_f32 v18, v18, v22
    v_add_f32 v19, v19, v23
    v_add_f32 v24, v24, v28
    v_add_f32 v25, v25, v29
    v_add_f32 v26, v26, v30
    v_add_f32 v27, v27, v31
    v_add_f32 v32, v32, v36
    v_add_f32 v33, v33, v37
    v_add_f32 v34, v34, v38
    v_add_f32 v35, v35, v39
    v_add_f32 v40, v40, v44
    v_add_f32 v41, v41, v45
    v_add_f32 v42, v42, v46
    v_add_f32 v43, v43, v47
    v_add_f32 v48, v48, v52
    v_add_f32 v49, v49, v53
    v_add_f32 v50, v50, v54
    v_add_f32 v51, v51, v55
    v_lshlrev_b32 v8, 16, v246
    v_lshlrev_b32 v9, 16, v218
    v_add_f32 v16, v16, v9
    v_add_f32 v16, v16, v8
    v_and_b32 v8, 0xffff0000, v246
    v_and_b32 v9, 0xffff0000, v218
    v_add_f32 v17, v17, v9
    v_add_f32 v17, v17, v8
    v_lshlrev_b32 v8, 16, v247
    v_lshlrev_b32 v9, 16, v219
    v_add_f32 v18, v18, v9
    v_add_f32 v18, v18, v8
    v_and_b32 v8, 0xffff0000, v247
    v_and_b32 v9, 0xffff0000, v219
    v_add_f32 v19, v19, v9
    v_add_f32 v19, v19, v8
    v_cvt_pk_bf16_f32 v60, v16, v17
    v_cvt_pk_bf16_f32 v61, v18, v19
    v_lshlrev_b32 v8, 16, v248
    v_lshlrev_b32 v9, 16, v220
    v_add_f32 v24, v24, v9
    v_add_f32 v24, v24, v8
    v_and_b32 v8, 0xffff0000, v248
    v_and_b32 v9, 0xffff0000, v220
    v_add_f32 v25, v25, v9
    v_add_f32 v25, v25, v8
    v_lshlrev_b32 v8, 16, v249
    v_lshlrev_b32 v9, 16, v221
    v_add_f32 v26, v26, v9
    v_add_f32 v26, v26, v8
    v_and_b32 v8, 0xffff0000, v249
    v_and_b32 v9, 0xffff0000, v221
    v_add_f32 v27, v27, v9
    v_add_f32 v27, v27, v8
    v_cvt_pk_bf16_f32 v62, v24, v25
    v_cvt_pk_bf16_f32 v63, v26, v27
    v_lshlrev_b32 v8, 16, v250
    v_lshlrev_b32 v9, 16, v222
    v_add_f32 v32, v32, v9
    v_add_f32 v32, v32, v8
    v_and_b32 v8, 0xffff0000, v250
    v_and_b32 v9, 0xffff0000, v222
    v_add_f32 v33, v33, v9
    v_add_f32 v33, v33, v8
    v_lshlrev_b32 v8, 16, v251
    v_lshlrev_b32 v9, 16, v223
    v_add_f32 v34, v34, v9
    v_add_f32 v34, v34, v8
    v_and_b32 v8, 0xffff0000, v251
    v_and_b32 v9, 0xffff0000, v223
    v_add_f32 v35, v35, v9
    v_add_f32 v35, v35, v8
    v_cvt_pk_bf16_f32 v64, v32, v33
    v_cvt_pk_bf16_f32 v65, v34, v35
    v_lshlrev_b32 v8, 16, v252
    v_lshlrev_b32 v9, 16, v224
    v_add_f32 v40, v40, v9
    v_add_f32 v40, v40, v8
    v_and_b32 v8, 0xffff0000, v252
    v_and_b32 v9, 0xffff0000, v224
    v_add_f32 v41, v41, v9
    v_add_f32 v41, v41, v8
    v_lshlrev_b32 v8, 16, v253
    v_lshlrev_b32 v9, 16, v225
    v_add_f32 v42, v42, v9
    v_add_f32 v42, v42, v8
    v_and_b32 v8, 0xffff0000, v253
    v_and_b32 v9, 0xffff0000, v225
    v_add_f32 v43, v43, v9
    v_add_f32 v43, v43, v8
    v_cvt_pk_bf16_f32 v66, v40, v41
    v_cvt_pk_bf16_f32 v67, v42, v43
    v_lshlrev_b32 v8, 16, v254
    v_lshlrev_b32 v9, 16, v226
    v_add_f32 v48, v48, v9
    v_add_f32 v48, v48, v8
    v_and_b32 v8, 0xffff0000, v254
    v_and_b32 v9, 0xffff0000, v226
    v_add_f32 v49, v49, v9
    v_add_f32 v49, v49, v8
    v_lshlrev_b32 v8, 16, v255
    v_lshlrev_b32 v9, 16, v227
    v_add_f32 v50, v50, v9
    v_add_f32 v50, v50, v8
    v_and_b32 v8, 0xffff0000, v255
    v_and_b32 v9, 0xffff0000, v227
    v_add_f32 v51, v51, v9
    v_add_f32 v51, v51, v8
    v_cvt_pk_bf16_f32 v68, v48, v49
    v_cvt_pk_bf16_f32 v69, v50, v51
    s_mul_i32 s64, s54, 2560
    s_add_u32 s64, s64, 32768
    v_and_b32 v3, 15, v2
    v_mul_u32_u24 v3, 160, v3
    v_lshrrev_b32 v4, 4, v2
    v_lshlrev_b32 v4, 3, v4
    v_add_u32 v3, v3, v4
    v_add_u32 v3, s64, v3
    s_add_u32 s60, s74, 0
    s_lshl_b32 s60, s60, 5
    v_add_u32 v4, s60, v3
    ds_write_b64 v4, v[60:61]
    s_add_u32 s60, s74, 1
    s_lshl_b32 s60, s60, 5
    v_add_u32 v4, s60, v3
    ds_write_b64 v4, v[62:63]
    s_add_u32 s60, s74, 2
    s_lshl_b32 s60, s60, 5
    v_add_u32 v4, s60, v3
    ds_write_b64 v4, v[64:65]
    s_add_u32 s60, s74, 3
    s_lshl_b32 s60, s60, 5
    v_add_u32 v4, s60, v3
    ds_write_b64 v4, v[66:67]
    s_add_u32 s60, s74, 4
    s_cmp_eq_u32 s60, 5
    s_cselect_b32 s60, 0, s60
    s_lshl_b32 s60, s60, 5
    v_add_u32 v4, s60, v3
    ds_write_b64 v4, v[68:69]
    s_waitcnt lgkmcnt(0)
    v_lshlrev_b32 v3, 4, v2
    v_add_u32 v3, s64, v3
    ds_read_b128 v[72:75], v3 offset:0
    ds_read_b128 v[76:79], v3 offset:1024
    ds_read_b128 v[80:83], v3 offset:2048
    s_lshl_b32 s60, s52, 8
    s_lshl_b32 s61, s75, 4
    s_add_u32 s60, s60, s61
    s_mul_i32 s60, s60, 1280
    s_mul_i32 s61, s57, 160
    s_add_u32 s60, s60, s61
    v_add_u32 v4, 0, v2
    v_mul_u32_u24 v5, 6554, v4
    v_lshrrev_b32 v5, 16, v5
    v_mul_u32_u24 v8, 10, v5
    v_sub_u32 v4, v4, v8
    v_mul_u32_u24 v5, 1280, v5
    v_lshlrev_b32 v4, 4, v4
    v_add_u32 v84, v5, v4
    v_add_u32 v4, 64, v2
    v_mul_u32_u24 v5, 6554, v4
    v_lshrrev_b32 v5, 16, v5
    v_mul_u32_u24 v8, 10, v5
    v_sub_u32 v4, v4, v8
    v_mul_u32_u24 v5, 1280, v5
    v_lshlrev_b32 v4, 4, v4
    v_add_u32 v85, v5, v4
    v_add_u32 v4, 128, v2
    v_mul_u32_u24 v5, 6554, v4
    v_lshrrev_b32 v5, 16, v5
    v_mul_u32_u24 v8, 10, v5
    v_sub_u32 v4, v4, v8
    v_mul_u32_u24 v5, 1280, v5
    v_lshlrev_b32 v4, 4, v4
    v_add_u32 v86, v5, v4
    s_waitcnt lgkmcnt(0)
    buffer_store_dwordx4 v[72:75], v84, s[40:43], s60 offen
    buffer_store_dwordx4 v[76:79], v85, s[40:43], s60 offen
    s_mov_b32 exec_hi, 0
    buffer_store_dwordx4 v[80:83], v86, s[40:43], s60 offen
    s_mov_b64 exec, -1
    s_branch L_end
L_p5_np:
    s_cmp_ge_u32 s54, 6
    s_cbranch_scc1 h6_140
    s_waitcnt vmcnt(45)
    s_barrier
    s_waitcnt vmcnt(30)
    s_barrier
    s_mov_b32 s69, 0
p5p_141:
    s_add_u32 s60, s68, s66
    s_mov_b32 m0, s60
    s_add_u32 s60, s60, 1024
    buffer_load_dwordx4 v16, s[36:39], s64 offen sc1 lds
    s_add_u32 s64, s64, 1024
    s_mov_b32 m0, s60
    s_add_u32 s60, s60, 1024
    buffer_load_dwordx4 v16, s[36:39], s64 offen sc1 lds
    s_add_u32 s64, s64, 1024
    s_mov_b32 m0, s60
    s_add_u32 s60, s60, 1024
    buffer_load_dwordx4 v16, s[36:39], s64 offen sc1 lds
    s_add_u32 s64, s64, 1024
    s_mov_b32 m0, s60
    s_add_u32 s60, s60, 1024
    buffer_load_dwordx4 v16, s[36:39], s64 offen sc1 lds
    s_add_u32 s64, s64, 1024
    s_mov_b32 m0, s60
    s_add_u32 s60, s60, 1024
    buffer_load_dwordx4 v16, s[36:39], s64 offen sc1 lds
    s_add_u32 s64, s64, 1024
    s_mov_b32 m0, s60
    s_add_u32 s60, s60, 1024
    buffer_load_dwordx4 v16, s[36:39], s64 offen sc1 lds
    s_add_u32 s64, s64, 1024
    s_mov_b32 m0, s60
    s_add_u32 s60, s60, 1024
    buffer_load_dwordx4 v16, s[36:39], s64 offen sc1 lds
    s_add_u32 s64, s64, 1024
    s_mov_b32 m0, s60
    s_add_u32 s60, s60, 1024
    buffer_load_dwordx4 v16, s[36:39], s64 offen sc1 lds
    s_add_u32 s64, s64, 1024
    s_mov_b32 m0, s60
    s_add_u32 s60, s60, 1024
    buffer_load_dwordx4 v16, s[36:39], s64 offen sc1 lds
    s_add_u32 s64, s64, 1024
    s_mov_b32 m0, s60
    s_add_u32 s60, s60, 1024
    buffer_load_dwordx4 v16, s[36:39], s64 offen sc1 lds
    s_add_u32 s64, s64, 1024
    s_mov_b32 m0, s60
    s_add_u32 s60, s60, 1024
    buffer_load_dwordx4 v16, s[36:39], s64 offen sc1 lds
    s_add_u32 s64, s64, 1024
    s_mov_b32 m0, s60
    s_add_u32 s60, s60, 1024
    buffer_load_dwordx4 v16, s[36:39], s64 offen sc1 lds
    s_add_u32 s64, s64, 1024
    s_mov_b32 m0, s60
    s_add_u32 s60, s60, 1024
    buffer_load_dwordx4 v16, s[36:39], s64 offen sc1 lds
    s_add_u32 s64, s64, 1024
    s_mov_b32 m0, s60
    s_add_u32 s60, s60, 1024
    buffer_load_dwordx4 v16, s[36:39], s64 offen sc1 lds
    s_add_u32 s64, s64, 1024
    s_mov_b32 m0, s60
    s_nop 0
    buffer_load_dwordx4 v16, s[36:39], s64 offen sc1 lds
    s_add_u32 s64, s64, 1024
    s_add_u32 s68, s68, 30720
    s_cmp_eq_u32 s68, 153600
    s_cselect_b32 s68, 0, s68
    s_waitcnt vmcnt(30)
    s_barrier
    s_add_u32 s69, s69, 1
    s_cmp_lt_u32 s69, 4
    s_cbranch_scc1 p5p_141
    s_waitcnt vmcnt(15)
    s_barrier
    s_waitcnt vmcnt(0)
    s_barrier
    s_barrier
    s_barrier
    s_barrier
    s_branch L_end
h6_140:
    s_barrier
    s_barrier
    s_barrier
    s_barrier
    s_barrier
    s_barrier
    s_barrier
    s_barrier
    s_barrier
    s_barrier
    s_barrier
L_end:
    s_endpgm
fmix_32:
    buffer_wbl2 sc1
    s_waitcnt vmcnt(0)
    buffer_store_dword v242, v241, s[36:39], s27 offen sc0 sc1
    s_branch fdone_33
fmix_106:
    buffer_wbl2 sc1
    s_waitcnt vmcnt(0)
    buffer_store_dword v242, v241, s[36:39], s27 offen sc0 sc1
    s_branch fdone_107
fmix_114:
    buffer_wbl2 sc1
    s_waitcnt vmcnt(0)
    buffer_store_dword v242, v241, s[36:39], s27 offen sc0 sc1
    s_branch fdone_115
fmix_134:
    buffer_wbl2 sc1
    s_waitcnt vmcnt(0)
    buffer_store_dword v242, v241, s[36:39], s27 offen sc0 sc1
    s_branch fdone_135
L_codeend:
.section .rodata,"a"
.p2align 6
.amdhsa_kernel sequential_preLN__sliding_block__dense_activation_gelu__prompt_kernel
  .amdhsa_next_free_vgpr 256
  .amdhsa_next_free_sgpr 102
  .amdhsa_accum_offset 256
  .amdhsa_group_segment_fixed_size 0
  .amdhsa_kernarg_size 88
  .amdhsa_user_sgpr_count 2
  .amdhsa_user_sgpr_kernarg_segment_ptr 1
  .amdhsa_system_sgpr_workgroup_id_x 1
.end_amdhsa_kernel
```
